```python
import torch

def _softmax(x, axis=-1):
    return torch.softmax(x, dim=axis)
def _gelu(x):
    return torch.nn.functional.gelu(x, approximate="tanh")
def _silu(x):
    return torch.nn.functional.silu(x)
def _sigmoid(x):
    return torch.sigmoid(x)
def _layernorm(x, axis=-1, eps=1e-5):
    m = x.mean(dim=axis, keepdim=True)
    v = x.var(dim=axis, keepdim=True, unbiased=False)
    return (x - m) / torch.sqrt(v + eps)
def _scatter_add(tgt, idx, src, axis=0):
    return tgt.clone().index_add_(axis, idx, src)
def _segment_sum(src, seg, n):
    out = torch.zeros((n,) + src.shape[1:], dtype=src.dtype)
    return out.index_add_(0, seg, src)
def _pad(x, pw):
    flat = tuple(v for pair in reversed(pw) for v in pair)
    return torch.nn.functional.pad(x, flat)

kernel_name = 'standalone__mha_block_cached__near_ridge'

def setup_inputs():

    _w = (lambda a: (lambda t: t.to(torch.bfloat16) if t.is_floating_point() else t)(torch.as_tensor(a)))
    B, Sq, D = 16, 64, 512
    H, Sk, Dh = 32, 64, 128
    return {
        "x": _w((lambda *s: torch.randn(*s, dtype=torch.bfloat16) * 0.8)(B, Sq, D)),
        "k_cache": _w((lambda *s: torch.randn(*s, dtype=torch.bfloat16) * 0.8)(B, H, Sk, Dh)),
        "v_cache": _w((lambda *s: torch.randn(*s, dtype=torch.bfloat16) * 0.05)(B, H, Sk, Dh)),
        "wq": _w((lambda *s: torch.randn(*s, dtype=torch.bfloat16) * 0.8)(D, H * Dh) * (D ** -0.5)),
        "wo": _w((lambda *s: torch.randn(*s, dtype=torch.bfloat16) * 0.05)(H * Dh, D) * ((H * Dh) ** -0.5)),
    }

def reference(x, k_cache, v_cache, wq, wo):
    B, Sq, D = x.shape
    H, Dh = 32, 128
    q = (lambda x, *d: x.permute(*d))((x @ wq).reshape(B, Sq, H, Dh), 0, 2, 1, 3)
    scores = torch.einsum("bhqd,bhkd->bhqk", q, k_cache) * (Dh ** -0.5)
    p = _softmax(scores, axis=-1)
    o = torch.einsum("bhqk,bhkd->bhqd", p, v_cache)
    return (lambda x, *d: x.permute(*d))(o, 0, 2, 1, 3).reshape(B, Sq, H * Dh) @ wo
```

```asm
; @launch grid=(256,1,1) block=(512,1,1) lds=163840
.amdgcn_target "amdgcn-amd-amdhsa--gfx950"
.text
.globl standalone__mha_block_cached__near_ridge_kernel
.p2align 8
.type standalone__mha_block_cached__near_ridge_kernel,@function
standalone__mha_block_cached__near_ridge_kernel:
    s_cmp_ge_u32 s2, 256
    s_cbranch_scc1 L_end
    s_load_dwordx16 s[16:31], s[0:1], 0
    v_lshrrev_b32 v1, 6, v0
    s_and_b32 s4, s2, 7
    s_lshr_b32 s5, s2, 3
    v_readfirstlane_b32 s3, v1
    v_and_b32 v0, 63, v0
    s_lshr_b32 s7, s5, 2
    s_and_b32 s6, s5, 3
    s_lshl_b32 s9, s4, 2
    s_add_u32 s8, s9, s6
    s_cmp_lt_u32 s3, 4
    s_cbranch_scc0 L_loader
    s_cmp_lg_u32 s3, 1
    s_cbranch_scc1 L_nopf
    s_getpc_b64 s[64:65]
    s_and_b32 s9, s5, 31
    s_mul_i32 s9, s9, 1024
    v_lshl_add_u32 v1, v0, 7, s9
    v_min_u32 v1, 0x5454, v1
    s_mov_b64 exec, 0xff
    global_load_dword v255, v1, s[64:65]
    s_mov_b64 exec, -1
L_nopf:
    s_cmp_eq_u32 s3, 0
    s_cbranch_scc1 L_pad0
    s_cmp_eq_u32 s3, 1
    s_cbranch_scc1 L_pad1
    s_cmp_eq_u32 s3, 2
    s_cbranch_scc1 L_pad2
    s_branch L_pad3
    s_branch L_compute
L_loader:
    s_sub_u32 s9, s3, 4
    v_lshrrev_b32 v1, 3, v0
    v_lshrrev_b32 v2, 4, v0
    v_and_b32 v3, 7, v0
    v_and_b32 v4, 15, v0
    v_lshlrev_b32 v5, 1, v2
    v_xor_b32 v5, v5, v4
    v_lshlrev_b32 v7, 4, v5
    v_lshl_add_u32 v5, v2, 13, v7
    s_lshl_b32 s10, s9, 17
    s_lshl_b32 s11, s8, 8
    s_add_u32 s10, s10, s11
    v_add_u32 v12, s10, v5
    v_xor_b32 v8, 0x80, v12
    v_xor_b32 v5, v3, v2
    v_lshlrev_b32 v5, 4, v5
    v_lshl_add_u32 v5, v1, 10, v5
    s_lshl_b32 s10, s7, 17
    s_lshl_b32 s11, s9, 14
    s_add_u32 s10, s10, s11
    v_add_u32 v10, s10, v5
    v_add_u32 v11, 0x2000, v10
    v_xor_b32 v11, 64, v11
    s_lshl_b32 s12, s9, 12
    s_lshl_b32 s14, s9, 11
    s_lshr_b32 s13, s7, 0
    s_add_u32 s13, s13, s6
    s_and_b32 s13, s13, 3
    s_lshl_b32 s13, s13, 2
    s_lshr_b32 s13, 0x4400, s13
    s_mul_i32 s10, s4, 3
    s_add_u32 s13, s13, s10
    s_andn2_b32 s67, 4, s4
    s_lshl_b32 s67, s67, 14
    s_mov_b32 s46, 0x400000
    s_mov_b32 s47, 0x20000
    s_mov_b32 s34, 0x100000
    s_mov_b32 s35, 0x20000
    s_mov_b32 s58, 0x2800000
    s_mov_b32 s59, 0x20000
    s_add_u32 s64, s13, 0
    s_and_b32 s64, s64, 7
    s_lshl_b32 s65, s64, 19
    s_lshl_b32 s64, s64, 7
    s_or_b32 s64, s64, s67
    s_add_u32 m0, s12, 0
    s_waitcnt lgkmcnt(0)
    s_mov_b64 s[44:45], s[22:23]
    s_mov_b64 s[32:33], s[16:17]
    buffer_load_dwordx4 v12, s[44:47], s65 offen lds
    s_add_u32 m0, s12, 1024
    s_add_u32 s65, s65, 32768
    buffer_load_dwordx4 v12, s[44:47], s65 offen lds
    s_add_u32 m0, s12, 2048
    s_add_u32 s65, s65, 32768
    buffer_load_dwordx4 v8, s[44:47], s65 offen lds
    s_add_u32 m0, s12, 3072
    s_add_u32 s65, s65, 32768
    buffer_load_dwordx4 v8, s[44:47], s65 offen lds
    s_add_u32 m0, s14, 49152
    s_nop 0
    buffer_load_dwordx4 v10, s[32:35], s64 offen lds
    s_add_u32 m0, s14, 50176
    s_nop 0
    buffer_load_dwordx4 v11, s[32:35], s64 offen lds
    s_add_u32 m0, s14, 57344
    s_xor_b32 s64, s64, 0x10000
    buffer_load_dwordx4 v10, s[32:35], s64 offen lds
    s_add_u32 m0, s14, 58368
    s_nop 0
    buffer_load_dwordx4 v11, s[32:35], s64 offen lds
    s_mov_b64 s[56:57], s[30:31]
    s_and_b32 s65, s5, 7
    s_add_u32 s65, s65, 0
    s_xor_b32 s65, s65, s4
    s_lshr_b32 s10, s9, 1
    s_or_b32 s65, s65, s10
    s_cbranch_scc1 L_noclr
    s_lshl_b32 s64, s5, 13
    s_add_u32 s64, s64, s12
    s_add_u32 s64, s64, 16777216
    v_mov_b32 v32, 0
    v_mov_b32 v33, 0
    v_mov_b32 v34, 0
    v_mov_b32 v35, 0
    v_lshrrev_b32 v28, 2, v0
    v_and_b32 v29, 3, v0
    v_lshlrev_b32 v29, 4, v29
    v_lshl_add_u32 v29, v28, 8, v29
    buffer_store_dwordx4 v[32:35], v29, s[56:59], s64 offen sc1
    buffer_store_dwordx4 v[32:35], v29, s[56:59], s64 offen offset:128 sc1
L_noclr:
    s_mov_b64 s[36:37], s[18:19]
    s_mov_b32 s38, 0x800000
    s_mov_b32 s39, 0x20000
    s_mov_b64 s[40:41], s[20:21]
    s_mov_b32 s42, 0x800000
    s_mov_b32 s43, 0x20000
    s_mov_b64 s[48:49], s[24:25]
    s_mov_b32 s50, 0x400000
    s_mov_b32 s51, 0x20000
    s_mov_b64 s[60:61], s[28:29]
    s_mov_b32 s62, 0x100
    s_mov_b32 s63, 0x20000
    v_xor_b32 v5, v4, v2
    v_lshlrev_b32 v5, 4, v5
    v_lshl_add_u32 v5, v2, 8, v5
    v_add_u32 v14, s12, v5
    v_xor_b32 v15, 64, v14
    v_xor_b32 v16, 128, v14
    v_xor_b32 v17, 192, v14
    v_lshl_add_u32 v5, v2, 8, v7
    v_add_u32 v18, s12, v5
    v_xor_b32 v19, 0x80, v18
    s_lshl_b32 s15, s7, 6
    s_add_u32 s15, s15, s8
    s_lshl_b32 s15, s15, 14
    s_lshl_b32 s10, s67, 3
    s_or_b32 s15, s15, s10
    s_xor_b32 s66, s4, s9
    s_xor_b32 s66, s66, 3
    s_and_b32 s66, s66, 3
    s_lshl_b32 s66, s66, 12
    v_lshl_add_u32 v5, v2, 10, v7
    s_lshl_b32 s10, s9, 14
    s_lshl_b32 s11, s6, 8
    s_add_u32 s10, s10, s11
    v_add_u32 v20, s10, v5
    v_xor_b32 v9, 0x80, v20
    s_lshr_b32 s10, s7, 1
    s_lshl_b32 s64, s4, 2
    s_add_u32 s10, s10, s64
    s_lshl_b32 s10, s10, 2
    s_add_u32 s10, s10, s9
    s_lshl_b32 s10, s10, 15
    v_lshl_add_u32 v13, v0, 7, s10
    v_lshl_add_u32 v21, v0, 4, s12
    s_lshl_b32 s10, s7, 4
    v_lshl_add_u32 v24, v0, 2, s10
    s_lshl_b32 s10, s2, 2
    s_add_u32 s10, s10, s9
    s_lshl_b32 s10, s10, 8
    s_add_u32 s10, s10, 16777216
    s_add_u32 s16, s30, s10
    s_addc_u32 s17, s31, 0
    s_lshl_b32 s10, s2, 5
    s_add_u32 s10, s10, s9
    s_lshl_b32 s10, s10, 10
    v_lshl_add_u32 v52, v0, 4, s10
    s_lshl_b32 s10, s9, 11
    s_add_u32 s10, s10, 65536
    v_lshl_add_u32 v53, v0, 4, s10
    v_lshrrev_b32 v54, 2, v0
    v_and_b32 v55, 3, v0
    v_lshlrev_b32 v55, 4, v55
    v_lshl_add_u32 v54, v54, 10, v55
    s_lshl_b32 s10, s7, 3
    s_add_u32 s10, s10, s4
    s_lshl_b32 s10, s10, 6
    s_add_u32 s10, s10, s6
    s_lshl_b32 s10, s10, 2
    s_add_u32 s10, s10, s9
    s_lshl_b32 s10, s10, 6
    v_add_u32 v54, s10, v54
    s_cmp_eq_u32 s6, 0
    s_cselect_b32 s24, 15, 0
    s_cmp_eq_u32 s6, 1
    s_cselect_b32 s25, 15, 0
    s_cmp_eq_u32 s6, 2
    s_cselect_b32 s26, 15, 0
    s_cmp_eq_u32 s6, 3
    s_cselect_b32 s27, 15, 0
    s_add_u32 s64, s13, 1
    s_and_b32 s64, s64, 7
    s_lshl_b32 s65, s64, 19
    s_lshl_b32 s64, s64, 7
    s_or_b32 s64, s64, s67
    s_add_u32 m0, s12, 16384
    s_nop 0
    buffer_load_dwordx4 v12, s[44:47], s65 offen lds
    s_add_u32 m0, s12, 17408
    s_add_u32 s65, s65, 32768
    buffer_load_dwordx4 v12, s[44:47], s65 offen lds
    s_add_u32 m0, s12, 18432
    s_add_u32 s65, s65, 32768
    buffer_load_dwordx4 v8, s[44:47], s65 offen lds
    s_add_u32 m0, s12, 19456
    s_add_u32 s65, s65, 32768
    buffer_load_dwordx4 v8, s[44:47], s65 offen lds
    s_add_u32 m0, s14, 65536
    s_nop 0
    buffer_load_dwordx4 v10, s[32:35], s64 offen lds
    s_add_u32 m0, s14, 66560
    s_nop 0
    buffer_load_dwordx4 v11, s[32:35], s64 offen lds
    s_add_u32 m0, s14, 73728
    s_xor_b32 s64, s64, 0x10000
    buffer_load_dwordx4 v10, s[32:35], s64 offen lds
    s_add_u32 m0, s14, 74752
    s_nop 0
    buffer_load_dwordx4 v11, s[32:35], s64 offen lds
    s_waitcnt vmcnt(8)
    s_barrier
    s_add_u32 s64, s13, 2
    s_and_b32 s64, s64, 7
    s_lshl_b32 s65, s64, 19
    s_lshl_b32 s64, s64, 7
    s_or_b32 s64, s64, s67
    s_add_u32 m0, s12, 32768
    s_nop 0
    buffer_load_dwordx4 v12, s[44:47], s65 offen lds
    s_add_u32 m0, s12, 33792
    s_add_u32 s65, s65, 32768
    buffer_load_dwordx4 v12, s[44:47], s65 offen lds
    s_add_u32 m0, s12, 34816
    s_add_u32 s65, s65, 32768
    buffer_load_dwordx4 v8, s[44:47], s65 offen lds
    s_add_u32 m0, s12, 35840
    s_add_u32 s65, s65, 32768
    buffer_load_dwordx4 v8, s[44:47], s65 offen lds
    s_add_u32 m0, s14, 81920
    s_nop 0
    buffer_load_dwordx4 v10, s[32:35], s64 offen lds
    s_add_u32 m0, s14, 82944
    s_nop 0
    buffer_load_dwordx4 v11, s[32:35], s64 offen lds
    s_add_u32 m0, s14, 90112
    s_xor_b32 s64, s64, 0x10000
    buffer_load_dwordx4 v10, s[32:35], s64 offen lds
    s_add_u32 m0, s14, 91136
    s_nop 0
    buffer_load_dwordx4 v11, s[32:35], s64 offen lds
    s_waitcnt vmcnt(8)
    s_barrier
    s_bitcmp1_b32 s7, 0
    s_cbranch_scc1 L_fb1
    s_add_u32 s64, s13, 3
    s_and_b32 s64, s64, 7
    s_lshl_b32 s65, s64, 19
    s_lshl_b32 s64, s64, 7
    s_or_b32 s64, s64, s67
    s_add_u32 m0, s12, 0
    s_nop 0
    buffer_load_dwordx4 v12, s[44:47], s65 offen lds
    s_add_u32 m0, s12, 1024
    s_add_u32 s65, s65, 32768
    buffer_load_dwordx4 v12, s[44:47], s65 offen lds
    s_add_u32 m0, s12, 2048
    s_add_u32 s65, s65, 32768
    buffer_load_dwordx4 v8, s[44:47], s65 offen lds
    s_add_u32 m0, s12, 3072
    s_add_u32 s65, s65, 32768
    buffer_load_dwordx4 v8, s[44:47], s65 offen lds
    s_add_u32 m0, s14, 49152
    s_nop 0
    buffer_load_dwordx4 v10, s[32:35], s64 offen lds
    s_add_u32 m0, s14, 50176
    s_nop 0
    buffer_load_dwordx4 v11, s[32:35], s64 offen lds
    s_add_u32 m0, s14, 57344
    s_xor_b32 s64, s64, 0x10000
    buffer_load_dwordx4 v10, s[32:35], s64 offen lds
    s_add_u32 m0, s14, 58368
    s_nop 0
    buffer_load_dwordx4 v11, s[32:35], s64 offen lds
    s_waitcnt vmcnt(8)
    s_barrier
    s_add_u32 s64, s13, 4
    s_and_b32 s64, s64, 7
    s_lshl_b32 s65, s64, 19
    s_lshl_b32 s64, s64, 7
    s_or_b32 s64, s64, s67
    s_add_u32 m0, s12, 16384
    s_nop 0
    buffer_load_dwordx4 v12, s[44:47], s65 offen lds
    s_add_u32 m0, s12, 17408
    s_add_u32 s65, s65, 32768
    buffer_load_dwordx4 v12, s[44:47], s65 offen lds
    s_add_u32 m0, s12, 18432
    s_add_u32 s65, s65, 32768
    buffer_load_dwordx4 v8, s[44:47], s65 offen lds
    s_add_u32 m0, s12, 19456
    s_add_u32 s65, s65, 32768
    buffer_load_dwordx4 v8, s[44:47], s65 offen lds
    s_add_u32 m0, s14, 65536
    s_nop 0
    buffer_load_dwordx4 v10, s[32:35], s64 offen lds
    s_add_u32 m0, s14, 66560
    s_nop 0
    buffer_load_dwordx4 v11, s[32:35], s64 offen lds
    s_add_u32 m0, s14, 73728
    s_xor_b32 s64, s64, 0x10000
    buffer_load_dwordx4 v10, s[32:35], s64 offen lds
    s_add_u32 m0, s14, 74752
    s_nop 0
    buffer_load_dwordx4 v11, s[32:35], s64 offen lds
    s_waitcnt vmcnt(8)
    s_barrier
    s_add_u32 s64, s13, 5
    s_and_b32 s64, s64, 7
    s_lshl_b32 s65, s64, 19
    s_lshl_b32 s64, s64, 7
    s_or_b32 s64, s64, s67
    s_add_u32 m0, s12, 32768
    s_nop 0
    buffer_load_dwordx4 v12, s[44:47], s65 offen lds
    s_add_u32 m0, s12, 33792
    s_add_u32 s65, s65, 32768
    buffer_load_dwordx4 v12, s[44:47], s65 offen lds
    s_add_u32 m0, s12, 34816
    s_add_u32 s65, s65, 32768
    buffer_load_dwordx4 v8, s[44:47], s65 offen lds
    s_add_u32 m0, s12, 35840
    s_add_u32 s65, s65, 32768
    buffer_load_dwordx4 v8, s[44:47], s65 offen lds
    s_add_u32 m0, s14, 81920
    s_nop 0
    buffer_load_dwordx4 v10, s[32:35], s64 offen lds
    s_add_u32 m0, s14, 82944
    s_nop 0
    buffer_load_dwordx4 v11, s[32:35], s64 offen lds
    s_add_u32 m0, s14, 90112
    s_xor_b32 s64, s64, 0x10000
    buffer_load_dwordx4 v10, s[32:35], s64 offen lds
    s_add_u32 m0, s14, 91136
    s_nop 0
    buffer_load_dwordx4 v11, s[32:35], s64 offen lds
    s_waitcnt vmcnt(8)
    s_barrier
    s_add_u32 s64, s13, 6
    s_and_b32 s64, s64, 7
    s_lshl_b32 s65, s64, 19
    s_lshl_b32 s64, s64, 7
    s_or_b32 s64, s64, s67
    s_add_u32 m0, s12, 0
    s_nop 0
    buffer_load_dwordx4 v12, s[44:47], s65 offen lds
    s_add_u32 m0, s12, 1024
    s_add_u32 s65, s65, 32768
    buffer_load_dwordx4 v12, s[44:47], s65 offen lds
    s_add_u32 m0, s12, 2048
    s_add_u32 s65, s65, 32768
    buffer_load_dwordx4 v8, s[44:47], s65 offen lds
    s_add_u32 m0, s12, 3072
    s_add_u32 s65, s65, 32768
    buffer_load_dwordx4 v8, s[44:47], s65 offen lds
    s_add_u32 m0, s14, 49152
    s_nop 0
    buffer_load_dwordx4 v10, s[32:35], s64 offen lds
    s_add_u32 m0, s14, 50176
    s_nop 0
    buffer_load_dwordx4 v11, s[32:35], s64 offen lds
    s_add_u32 m0, s14, 57344
    s_xor_b32 s64, s64, 0x10000
    buffer_load_dwordx4 v10, s[32:35], s64 offen lds
    s_add_u32 m0, s14, 58368
    s_nop 0
    buffer_load_dwordx4 v11, s[32:35], s64 offen lds
    s_waitcnt vmcnt(8)
    s_barrier
    s_add_u32 s64, s13, 7
    s_and_b32 s64, s64, 7
    s_lshl_b32 s65, s64, 19
    s_lshl_b32 s64, s64, 7
    s_or_b32 s64, s64, s67
    s_add_u32 m0, s12, 16384
    s_nop 0
    buffer_load_dwordx4 v12, s[44:47], s65 offen lds
    s_add_u32 m0, s12, 17408
    s_add_u32 s65, s65, 32768
    buffer_load_dwordx4 v12, s[44:47], s65 offen lds
    s_add_u32 m0, s12, 18432
    s_add_u32 s65, s65, 32768
    buffer_load_dwordx4 v8, s[44:47], s65 offen lds
    s_add_u32 m0, s12, 19456
    s_add_u32 s65, s65, 32768
    buffer_load_dwordx4 v8, s[44:47], s65 offen lds
    s_add_u32 m0, s14, 65536
    s_nop 0
    buffer_load_dwordx4 v10, s[32:35], s64 offen lds
    s_add_u32 m0, s14, 66560
    s_nop 0
    buffer_load_dwordx4 v11, s[32:35], s64 offen lds
    s_add_u32 m0, s14, 73728
    s_xor_b32 s64, s64, 0x10000
    buffer_load_dwordx4 v10, s[32:35], s64 offen lds
    s_add_u32 m0, s14, 74752
    s_nop 0
    buffer_load_dwordx4 v11, s[32:35], s64 offen lds
    s_waitcnt vmcnt(8)
    s_barrier
    s_add_u32 m0, s12, 98304
    s_xor_b32 s64, s15, 0
    buffer_load_dwordx4 v14, s[36:39], s64 offen offset:0 nt lds
    buffer_load_dwordx4 v15, s[36:39], s64 offen offset:1024 nt lds
    buffer_load_dwordx4 v16, s[36:39], s64 offen offset:2048 nt lds
    buffer_load_dwordx4 v17, s[36:39], s64 offen offset:3072 nt lds
    s_add_u32 m0, s12, 114688
    s_xor_b32 s64, s15, 0
    buffer_load_dwordx4 v18, s[40:43], s64 offen offset:0 nt lds
    buffer_load_dwordx4 v19, s[40:43], s64 offen offset:1024 nt lds
    buffer_load_dwordx4 v18, s[40:43], s64 offen offset:2048 nt lds
    buffer_load_dwordx4 v19, s[40:43], s64 offen offset:3072 nt lds
    s_waitcnt vmcnt(8)
    s_barrier
    s_lshl_b32 s65, s6, 3
    s_lshr_b32 s64, 0x58302800, s65
    s_lshr_b32 s65, 0x28280828, s65
    s_and_b32 s64, s64, 0xff
    s_lshl_b32 s64, s64, 7
    s_bfm_b64 exec, s65, 0
    buffer_load_dword v30, v13, s[48:51], s64 offen
    s_mov_b64 exec, -1
    s_add_u32 m0, s12, 131072
    s_xor_b32 s64, s15, 524288
    buffer_load_dwordx4 v14, s[36:39], s64 offen offset:0 nt lds
    buffer_load_dwordx4 v15, s[36:39], s64 offen offset:1024 nt lds
    buffer_load_dwordx4 v16, s[36:39], s64 offen offset:2048 nt lds
    buffer_load_dwordx4 v17, s[36:39], s64 offen offset:3072 nt lds
    s_waitcnt vmcnt(5)
    s_barrier
    s_add_u32 m0, s12, 147456
    s_xor_b32 s64, s15, 524288
    buffer_load_dwordx4 v18, s[40:43], s64 offen offset:0 nt lds
    buffer_load_dwordx4 v19, s[40:43], s64 offen offset:1024 nt lds
    buffer_load_dwordx4 v18, s[40:43], s64 offen offset:2048 nt lds
    buffer_load_dwordx4 v19, s[40:43], s64 offen offset:3072 nt lds
    s_branch L_fj1
L_pad0:
    s_branch L_pad4
    s_nop 0
L_pg0:
L_fb1:
    s_add_u32 m0, s12, 98304
    s_xor_b32 s64, s15, 0
    buffer_load_dwordx4 v14, s[36:39], s64 offen offset:0 nt lds
    buffer_load_dwordx4 v15, s[36:39], s64 offen offset:1024 nt lds
    buffer_load_dwordx4 v16, s[36:39], s64 offen offset:2048 nt lds
    buffer_load_dwordx4 v17, s[36:39], s64 offen offset:3072 nt lds
    s_add_u32 m0, s12, 114688
    s_xor_b32 s64, s15, 0
    buffer_load_dwordx4 v18, s[40:43], s64 offen offset:0 nt lds
    buffer_load_dwordx4 v19, s[40:43], s64 offen offset:1024 nt lds
    buffer_load_dwordx4 v18, s[40:43], s64 offen offset:2048 nt lds
    buffer_load_dwordx4 v19, s[40:43], s64 offen offset:3072 nt lds
    s_waitcnt vmcnt(8)
    s_barrier
    s_add_u32 s64, s13, 3
    s_and_b32 s64, s64, 7
    s_lshl_b32 s65, s64, 19
    s_lshl_b32 s64, s64, 7
    s_or_b32 s64, s64, s67
    s_add_u32 m0, s12, 0
    s_nop 0
    buffer_load_dwordx4 v12, s[44:47], s65 offen lds
    s_add_u32 m0, s12, 1024
    s_add_u32 s65, s65, 32768
    buffer_load_dwordx4 v12, s[44:47], s65 offen lds
    s_add_u32 m0, s12, 2048
    s_add_u32 s65, s65, 32768
    buffer_load_dwordx4 v8, s[44:47], s65 offen lds
    s_add_u32 m0, s12, 3072
    s_add_u32 s65, s65, 32768
    buffer_load_dwordx4 v8, s[44:47], s65 offen lds
    s_add_u32 m0, s14, 49152
    s_nop 0
    buffer_load_dwordx4 v10, s[32:35], s64 offen lds
    s_add_u32 m0, s14, 50176
    s_nop 0
    buffer_load_dwordx4 v11, s[32:35], s64 offen lds
    s_add_u32 m0, s14, 57344
    s_xor_b32 s64, s64, 0x10000
    buffer_load_dwordx4 v10, s[32:35], s64 offen lds
    s_add_u32 m0, s14, 58368
    s_nop 0
    buffer_load_dwordx4 v11, s[32:35], s64 offen lds
    s_branch L_pg1
.p2align 12
L_pad1:
    s_branch L_pad5
    s_nop 0
L_pg1:
    s_add_u32 m0, s12, 131072
    s_xor_b32 s64, s15, 524288
    buffer_load_dwordx4 v14, s[36:39], s64 offen offset:0 nt lds
    buffer_load_dwordx4 v15, s[36:39], s64 offen offset:1024 nt lds
    buffer_load_dwordx4 v16, s[36:39], s64 offen offset:2048 nt lds
    buffer_load_dwordx4 v17, s[36:39], s64 offen offset:3072 nt lds
    s_add_u32 m0, s12, 147456
    s_xor_b32 s64, s15, 524288
    buffer_load_dwordx4 v18, s[40:43], s64 offen offset:0 nt lds
    buffer_load_dwordx4 v19, s[40:43], s64 offen offset:1024 nt lds
    buffer_load_dwordx4 v18, s[40:43], s64 offen offset:2048 nt lds
    buffer_load_dwordx4 v19, s[40:43], s64 offen offset:3072 nt lds
    s_lshl_b32 s65, s6, 3
    s_lshr_b32 s64, 0xd8b0a880, s65
    s_lshr_b32 s65, 0x28280828, s65
    s_and_b32 s64, s64, 0xff
    s_lshl_b32 s64, s64, 7
    s_bfm_b64 exec, s65, 0
    buffer_load_dword v30, v13, s[48:51], s64 offen
    s_mov_b64 exec, -1
    s_waitcnt vmcnt(9)
    s_barrier
    s_add_u32 s64, s13, 4
    s_and_b32 s64, s64, 7
    s_lshl_b32 s65, s64, 19
    s_lshl_b32 s64, s64, 7
    s_or_b32 s64, s64, s67
    s_add_u32 m0, s12, 16384
    s_nop 0
    buffer_load_dwordx4 v12, s[44:47], s65 offen lds
    s_add_u32 m0, s12, 17408
    s_add_u32 s65, s65, 32768
    buffer_load_dwordx4 v12, s[44:47], s65 offen lds
    s_add_u32 m0, s12, 18432
    s_add_u32 s65, s65, 32768
    buffer_load_dwordx4 v8, s[44:47], s65 offen lds
    s_add_u32 m0, s12, 19456
    s_add_u32 s65, s65, 32768
    buffer_load_dwordx4 v8, s[44:47], s65 offen lds
    s_add_u32 m0, s14, 65536
    s_nop 0
    buffer_load_dwordx4 v10, s[32:35], s64 offen lds
    s_add_u32 m0, s14, 66560
    s_nop 0
    buffer_load_dwordx4 v11, s[32:35], s64 offen lds
    s_add_u32 m0, s14, 73728
    s_xor_b32 s64, s64, 0x10000
    buffer_load_dwordx4 v10, s[32:35], s64 offen lds
    s_add_u32 m0, s14, 74752
    s_nop 0
    buffer_load_dwordx4 v11, s[32:35], s64 offen lds
    s_add_u32 s64, s13, 5
    s_and_b32 s64, s64, 7
    s_lshl_b32 s65, s64, 19
    s_lshl_b32 s64, s64, 7
    s_or_b32 s64, s64, s67
    s_add_u32 m0, s12, 32768
    s_nop 0
    buffer_load_dwordx4 v12, s[44:47], s65 offen lds
    s_add_u32 m0, s12, 33792
    s_add_u32 s65, s65, 32768
    buffer_load_dwordx4 v12, s[44:47], s65 offen lds
    s_add_u32 m0, s12, 34816
    s_add_u32 s65, s65, 32768
    buffer_load_dwordx4 v8, s[44:47], s65 offen lds
    s_add_u32 m0, s12, 35840
    s_add_u32 s65, s65, 32768
    buffer_load_dwordx4 v8, s[44:47], s65 offen lds
    s_add_u32 m0, s14, 81920
    s_nop 0
    buffer_load_dwordx4 v10, s[32:35], s64 offen lds
    s_add_u32 m0, s14, 82944
    s_nop 0
    buffer_load_dwordx4 v11, s[32:35], s64 offen lds
    s_add_u32 m0, s14, 90112
    s_xor_b32 s64, s64, 0x10000
    buffer_load_dwordx4 v10, s[32:35], s64 offen lds
    s_add_u32 m0, s14, 91136
    s_nop 0
    buffer_load_dwordx4 v11, s[32:35], s64 offen lds
    s_waitcnt vmcnt(8)
    s_barrier
    s_add_u32 s64, s13, 6
    s_and_b32 s64, s64, 7
    s_lshl_b32 s65, s64, 19
    s_lshl_b32 s64, s64, 7
    s_or_b32 s64, s64, s67
    s_add_u32 m0, s12, 0
    s_nop 0
    buffer_load_dwordx4 v12, s[44:47], s65 offen lds
    s_add_u32 m0, s12, 1024
    s_add_u32 s65, s65, 32768
    buffer_load_dwordx4 v12, s[44:47], s65 offen lds
    s_add_u32 m0, s12, 2048
    s_add_u32 s65, s65, 32768
    buffer_load_dwordx4 v8, s[44:47], s65 offen lds
    s_add_u32 m0, s12, 3072
    s_add_u32 s65, s65, 32768
    buffer_load_dwordx4 v8, s[44:47], s65 offen lds
    s_add_u32 m0, s14, 49152
    s_nop 0
    buffer_load_dwordx4 v10, s[32:35], s64 offen lds
    s_add_u32 m0, s14, 50176
    s_nop 0
    buffer_load_dwordx4 v11, s[32:35], s64 offen lds
    s_add_u32 m0, s14, 57344
    s_xor_b32 s64, s64, 0x10000
    buffer_load_dwordx4 v10, s[32:35], s64 offen lds
    s_add_u32 m0, s14, 58368
    s_nop 0
    buffer_load_dwordx4 v11, s[32:35], s64 offen lds
    s_waitcnt vmcnt(8)
    s_barrier
    s_add_u32 s64, s13, 7
    s_and_b32 s64, s64, 7
    s_lshl_b32 s65, s64, 19
    s_lshl_b32 s64, s64, 7
    s_or_b32 s64, s64, s67
    s_add_u32 m0, s12, 16384
    s_nop 0
    buffer_load_dwordx4 v12, s[44:47], s65 offen lds
    s_add_u32 m0, s12, 17408
    s_add_u32 s65, s65, 32768
    buffer_load_dwordx4 v12, s[44:47], s65 offen lds
    s_add_u32 m0, s12, 18432
    s_add_u32 s65, s65, 32768
    buffer_load_dwordx4 v8, s[44:47], s65 offen lds
    s_add_u32 m0, s12, 19456
    s_add_u32 s65, s65, 32768
    buffer_load_dwordx4 v8, s[44:47], s65 offen lds
    s_add_u32 m0, s14, 65536
    s_nop 0
    buffer_load_dwordx4 v10, s[32:35], s64 offen lds
    s_add_u32 m0, s14, 66560
    s_nop 0
    buffer_load_dwordx4 v11, s[32:35], s64 offen lds
    s_add_u32 m0, s14, 73728
    s_xor_b32 s64, s64, 0x10000
    buffer_load_dwordx4 v10, s[32:35], s64 offen lds
    s_add_u32 m0, s14, 74752
    s_nop 0
    buffer_load_dwordx4 v11, s[32:35], s64 offen lds
    s_waitcnt vmcnt(8)
    s_barrier
    s_waitcnt vmcnt(0)
    s_barrier
    s_barrier
L_fj1:
    s_cmp_lg_u32 s9, 0
    s_cbranch_scc1 L_noed1
    s_mov_b64 exec, 15
    buffer_load_dword v27, v24, s[60:63], 0 offen sc1
    s_mov_b64 exec, -1
L_noed1:
    s_add_u32 s64, s6, 0
    s_and_b32 s64, s64, 3
    s_lshl_b32 s65, s4, 2
    s_add_u32 s64, s64, s65
    s_lshl_b32 s64, s64, 17
    s_add_u32 m0, s12, 0
    s_nop 0
    buffer_load_dwordx4 v20, s[48:51], s64 offen lds
    s_add_u32 m0, s12, 1024
    s_add_u32 s64, s64, 4096
    buffer_load_dwordx4 v9, s[48:51], s64 offen lds
    s_add_u32 m0, s12, 2048
    s_add_u32 s64, s64, 4096
    buffer_load_dwordx4 v20, s[48:51], s64 offen lds
    s_add_u32 m0, s12, 3072
    s_add_u32 s64, s64, 4096
    buffer_load_dwordx4 v9, s[48:51], s64 offen lds
    s_add_u32 s64, s6, 0
    s_and_b32 s64, s64, 3
    s_lshl_b32 s65, s4, 2
    s_add_u32 s64, s64, s65
    s_lshl_b32 s64, s64, 17
    s_add_u32 s64, s64, 0x10000
    s_add_u32 m0, s12, 16384
    s_nop 0
    buffer_load_dwordx4 v20, s[48:51], s64 offen lds
    s_add_u32 m0, s12, 17408
    s_add_u32 s64, s64, 4096
    buffer_load_dwordx4 v9, s[48:51], s64 offen lds
    s_add_u32 m0, s12, 18432
    s_add_u32 s64, s64, 4096
    buffer_load_dwordx4 v20, s[48:51], s64 offen lds
    s_add_u32 m0, s12, 19456
    s_add_u32 s64, s64, 4096
    buffer_load_dwordx4 v9, s[48:51], s64 offen lds
    s_add_u32 s64, s6, 1
    s_and_b32 s64, s64, 3
    s_lshl_b32 s65, s4, 2
    s_add_u32 s64, s64, s65
    s_lshl_b32 s64, s64, 17
    s_add_u32 m0, s12, 32768
    s_nop 0
    buffer_load_dwordx4 v20, s[48:51], s64 offen lds
    s_add_u32 m0, s12, 33792
    s_add_u32 s64, s64, 4096
    buffer_load_dwordx4 v9, s[48:51], s64 offen lds
    s_add_u32 m0, s12, 34816
    s_add_u32 s64, s64, 4096
    buffer_load_dwordx4 v20, s[48:51], s64 offen lds
    s_add_u32 m0, s12, 35840
    s_add_u32 s64, s64, 4096
    buffer_load_dwordx4 v9, s[48:51], s64 offen lds
    s_add_u32 s64, s6, 1
    s_and_b32 s64, s64, 3
    s_lshl_b32 s65, s4, 2
    s_add_u32 s64, s64, s65
    s_lshl_b32 s64, s64, 17
    s_add_u32 s64, s64, 0x10000
    s_add_u32 m0, s12, 49152
    s_nop 0
    buffer_load_dwordx4 v20, s[48:51], s64 offen lds
    s_add_u32 m0, s12, 50176
    s_add_u32 s64, s64, 4096
    buffer_load_dwordx4 v9, s[48:51], s64 offen lds
    s_add_u32 m0, s12, 51200
    s_add_u32 s64, s64, 4096
    buffer_load_dwordx4 v20, s[48:51], s64 offen lds
    s_add_u32 m0, s12, 52224
    s_add_u32 s64, s64, 4096
    buffer_load_dwordx4 v9, s[48:51], s64 offen lds
    s_cmp_lg_u32 s9, 0
    s_cbranch_scc1 L_pollok1
    s_waitcnt vmcnt(16)
    s_mov_b32 s65, 0x40000
    s_mov_b64 exec, 15
    s_branch L_pollin1
L_poll1:
    buffer_load_dword v27, v24, s[60:63], 0 offen sc1
    s_waitcnt vmcnt(0)
L_pollin1:
    v_cmp_gt_u32 vcc, 1, v27
    s_cbranch_vccz L_pollok1
    s_sub_u32 s65, s65, 1
    s_cbranch_scc0 L_poll1
L_pollok1:
    s_mov_b64 exec, -1
    s_waitcnt vmcnt(16)
    s_barrier
    s_waitcnt vmcnt(0)
    s_barrier
    s_add_u32 s64, s6, 2
    s_and_b32 s64, s64, 3
    s_lshl_b32 s65, s4, 2
    s_add_u32 s64, s64, s65
    s_lshl_b32 s64, s64, 17
    s_add_u32 m0, s12, 98304
    s_nop 0
    buffer_load_dwordx4 v20, s[48:51], s64 offen lds
    s_add_u32 m0, s12, 99328
    s_add_u32 s64, s64, 4096
    buffer_load_dwordx4 v9, s[48:51], s64 offen lds
    s_add_u32 m0, s12, 100352
    s_add_u32 s64, s64, 4096
    buffer_load_dwordx4 v20, s[48:51], s64 offen lds
    s_add_u32 m0, s12, 101376
    s_add_u32 s64, s64, 4096
    buffer_load_dwordx4 v9, s[48:51], s64 offen lds
    s_add_u32 s64, s6, 2
    s_and_b32 s64, s64, 3
    s_lshl_b32 s65, s4, 2
    s_add_u32 s64, s64, s65
    s_lshl_b32 s64, s64, 17
    s_add_u32 s64, s64, 0x10000
    s_add_u32 m0, s12, 114688
    s_nop 0
    buffer_load_dwordx4 v20, s[48:51], s64 offen lds
    s_add_u32 m0, s12, 115712
    s_add_u32 s64, s64, 4096
    buffer_load_dwordx4 v9, s[48:51], s64 offen lds
    s_add_u32 m0, s12, 116736
    s_add_u32 s64, s64, 4096
    buffer_load_dwordx4 v20, s[48:51], s64 offen lds
    s_add_u32 m0, s12, 117760
    s_add_u32 s64, s64, 4096
    buffer_load_dwordx4 v9, s[48:51], s64 offen lds
    s_load_dwordx4 s[20:23], s[16:17], 0 glc
    s_barrier
    s_add_u32 s64, s6, 3
    s_and_b32 s64, s64, 3
    s_lshl_b32 s65, s4, 2
    s_add_u32 s64, s64, s65
    s_lshl_b32 s64, s64, 17
    s_add_u32 m0, s12, 131072
    s_nop 0
    buffer_load_dwordx4 v20, s[48:51], s64 offen lds
    s_add_u32 m0, s12, 132096
    s_add_u32 s64, s64, 4096
    buffer_load_dwordx4 v9, s[48:51], s64 offen lds
    s_add_u32 m0, s12, 133120
    s_add_u32 s64, s64, 4096
    buffer_load_dwordx4 v20, s[48:51], s64 offen lds
    s_add_u32 m0, s12, 134144
    s_add_u32 s64, s64, 4096
    buffer_load_dwordx4 v9, s[48:51], s64 offen lds
    s_mov_b32 s65, 0x40000
    s_branch L_pollin2
L_poll2:
    s_load_dwordx4 s[20:23], s[16:17], 0 glc
L_pollin2:
    s_waitcnt lgkmcnt(0)
    s_or_b64 s[20:21], s[20:21], s[24:25]
    s_or_b64 s[22:23], s[22:23], s[26:27]
    s_min_u32 s20, s20, s22
    s_min_u32 s21, s21, s23
    s_min_u32 s20, s20, s21
    s_cmp_ge_u32 s20, 1
    s_cbranch_scc1 L_pollok2
    s_sub_u32 s65, s65, 1
    s_cbranch_scc0 L_poll2
L_pollok2:
    s_add_u32 s64, s6, 1
    s_and_b32 s64, s64, 3
    s_lshl_b32 s65, s4, 2
    s_add_u32 s64, s64, s65
    s_lshl_b32 s65, s7, 6
    s_add_u32 s64, s64, s65
    s_lshl_b32 s64, s64, 14
    s_add_u32 m0, s66, 0
    s_nop 0
    buffer_load_dwordx4 v21, s[56:59], s64 offen offset:0 sc1 lds
    buffer_load_dwordx4 v21, s[56:59], s64 offen offset:1024 sc1 lds
    buffer_load_dwordx4 v21, s[56:59], s64 offen offset:2048 sc1 lds
    buffer_load_dwordx4 v21, s[56:59], s64 offen offset:3072 sc1 lds
    s_add_u32 s64, s6, 3
    s_and_b32 s64, s64, 3
    s_lshl_b32 s65, s4, 2
    s_add_u32 s64, s64, s65
    s_lshl_b32 s64, s64, 17
    s_add_u32 s64, s64, 0x10000
    s_add_u32 m0, s12, 147456
    s_nop 0
    buffer_load_dwordx4 v20, s[48:51], s64 offen lds
    s_add_u32 m0, s12, 148480
    s_add_u32 s64, s64, 4096
    buffer_load_dwordx4 v9, s[48:51], s64 offen lds
    s_add_u32 m0, s12, 149504
    s_add_u32 s64, s64, 4096
    buffer_load_dwordx4 v20, s[48:51], s64 offen lds
    s_add_u32 m0, s12, 150528
    s_add_u32 s64, s64, 4096
    buffer_load_dwordx4 v9, s[48:51], s64 offen lds
    s_add_u32 s64, s6, 2
    s_and_b32 s64, s64, 3
    s_lshl_b32 s65, s4, 2
    s_add_u32 s64, s64, s65
    s_lshl_b32 s65, s7, 6
    s_add_u32 s64, s64, s65
    s_lshl_b32 s64, s64, 14
    s_add_u32 m0, s66, 16384
    s_nop 0
    buffer_load_dwordx4 v21, s[56:59], s64 offen offset:0 sc1 lds
    buffer_load_dwordx4 v21, s[56:59], s64 offen offset:1024 sc1 lds
    buffer_load_dwordx4 v21, s[56:59], s64 offen offset:2048 sc1 lds
    buffer_load_dwordx4 v21, s[56:59], s64 offen offset:3072 sc1 lds
    s_waitcnt vmcnt(8)
    s_barrier
    s_load_dwordx4 s[20:23], s[16:17], 0 glc
    s_add_u32 s64, s6, 3
    s_and_b32 s64, s64, 3
    s_lshl_b32 s65, s4, 2
    s_add_u32 s64, s64, s65
    s_lshl_b32 s65, s7, 6
    s_add_u32 s64, s64, s65
    s_lshl_b32 s64, s64, 14
    s_add_u32 m0, s66, 32768
    s_nop 0
    buffer_load_dwordx4 v21, s[56:59], s64 offen offset:0 sc1 lds
    buffer_load_dwordx4 v21, s[56:59], s64 offen offset:1024 sc1 lds
    buffer_load_dwordx4 v21, s[56:59], s64 offen offset:2048 sc1 lds
    buffer_load_dwordx4 v21, s[56:59], s64 offen offset:3072 sc1 lds
    s_mov_b32 s65, 0x40000
    s_branch L_pollin3
L_poll3:
    s_load_dwordx4 s[20:23], s[16:17], 0 glc
L_pollin3:
    s_waitcnt lgkmcnt(0)
    s_or_b64 s[20:21], s[20:21], s[24:25]
    s_or_b64 s[22:23], s[22:23], s[26:27]
    s_min_u32 s20, s20, s22
    s_min_u32 s21, s21, s23
    s_min_u32 s20, s20, s21
    s_cmp_ge_u32 s20, 2
    s_cbranch_scc1 L_pollok3
    s_sub_u32 s65, s65, 1
    s_cbranch_scc0 L_poll3
L_pollok3:
    s_add_u32 s64, s6, 1
    s_and_b32 s64, s64, 3
    s_lshl_b32 s65, s4, 2
    s_add_u32 s64, s64, s65
    s_lshl_b32 s65, s7, 6
    s_add_u32 s64, s64, s65
    s_add_u32 s64, s64, 32
    s_lshl_b32 s64, s64, 14
    s_add_u32 m0, s66, 49152
    s_nop 0
    buffer_load_dwordx4 v21, s[56:59], s64 offen offset:0 sc1 lds
    buffer_load_dwordx4 v21, s[56:59], s64 offen offset:1024 sc1 lds
    buffer_load_dwordx4 v21, s[56:59], s64 offen offset:2048 sc1 lds
    buffer_load_dwordx4 v21, s[56:59], s64 offen offset:3072 sc1 lds
    s_waitcnt vmcnt(8)
    s_barrier
    s_add_u32 s64, s6, 2
    s_and_b32 s64, s64, 3
    s_lshl_b32 s65, s4, 2
    s_add_u32 s64, s64, s65
    s_lshl_b32 s65, s7, 6
    s_add_u32 s64, s64, s65
    s_add_u32 s64, s64, 32
    s_lshl_b32 s64, s64, 14
    s_add_u32 m0, s66, 98304
    s_nop 0
    buffer_load_dwordx4 v21, s[56:59], s64 offen offset:0 sc1 lds
    buffer_load_dwordx4 v21, s[56:59], s64 offen offset:1024 sc1 lds
    buffer_load_dwordx4 v21, s[56:59], s64 offen offset:2048 sc1 lds
    buffer_load_dwordx4 v21, s[56:59], s64 offen offset:3072 sc1 lds
    s_add_u32 s64, s6, 3
    s_and_b32 s64, s64, 3
    s_lshl_b32 s65, s4, 2
    s_add_u32 s64, s64, s65
    s_lshl_b32 s65, s7, 6
    s_add_u32 s64, s64, s65
    s_add_u32 s64, s64, 32
    s_lshl_b32 s64, s64, 14
    s_add_u32 m0, s66, 114688
    s_nop 0
    buffer_load_dwordx4 v21, s[56:59], s64 offen offset:0 sc1 lds
    buffer_load_dwordx4 v21, s[56:59], s64 offen offset:1024 sc1 lds
    buffer_load_dwordx4 v21, s[56:59], s64 offen offset:2048 sc1 lds
    buffer_load_dwordx4 v21, s[56:59], s64 offen offset:3072 sc1 lds
    s_waitcnt vmcnt(12)
    s_barrier
    s_waitcnt vmcnt(8)
    s_barrier
    s_waitcnt vmcnt(0)
    s_barrier
    s_mov_b32 s65, 0x40000
L_poll4:
    s_load_dwordx4 s[20:23], s[16:17], 32 glc
L_pollin4:
    s_waitcnt lgkmcnt(0)
    s_min_u32 s20, s20, s22
    s_min_u32 s21, s21, s23
    s_min_u32 s20, s20, s21
    s_cmp_ge_u32 s20, 1
    s_cbranch_scc1 L_pollok4
    s_sub_u32 s65, s65, 1
    s_cbranch_scc0 L_poll4
L_pollok4:
    s_mov_b32 s64, 8388608
    buffer_load_dwordx4 v[32:35], v52, s[56:59], s64 offen sc1
    s_mov_b32 s64, 8392704
    buffer_load_dwordx4 v[36:39], v52, s[56:59], s64 offen sc1
    s_mov_b32 s64, 8396800
    buffer_load_dwordx4 v[40:43], v52, s[56:59], s64 offen sc1
    s_mov_b32 s64, 8400896
    buffer_load_dwordx4 v[44:47], v52, s[56:59], s64 offen sc1
    s_waitcnt vmcnt(3)
    v_lshlrev_b32 v72, 16, v32
    v_and_b32 v73, 0xffff0000, v32
    v_lshlrev_b32 v74, 16, v33
    v_and_b32 v75, 0xffff0000, v33
    v_lshlrev_b32 v76, 16, v34
    v_and_b32 v77, 0xffff0000, v34
    v_lshlrev_b32 v78, 16, v35
    v_and_b32 v79, 0xffff0000, v35
    s_waitcnt vmcnt(2)
    v_lshlrev_b32 v64, 16, v36
    v_and_b32 v65, 0xffff0000, v36
    v_lshlrev_b32 v66, 16, v37
    v_and_b32 v67, 0xffff0000, v37
    v_lshlrev_b32 v68, 16, v38
    v_and_b32 v69, 0xffff0000, v38
    v_lshlrev_b32 v70, 16, v39
    v_and_b32 v71, 0xffff0000, v39
    v_pk_add_f32 v[72:73], v[72:73], v[64:65]
    v_pk_add_f32 v[74:75], v[74:75], v[66:67]
    v_pk_add_f32 v[76:77], v[76:77], v[68:69]
    v_pk_add_f32 v[78:79], v[78:79], v[70:71]
    s_waitcnt vmcnt(1)
    v_lshlrev_b32 v64, 16, v40
    v_and_b32 v65, 0xffff0000, v40
    v_lshlrev_b32 v66, 16, v41
    v_and_b32 v67, 0xffff0000, v41
    v_lshlrev_b32 v68, 16, v42
    v_and_b32 v69, 0xffff0000, v42
    v_lshlrev_b32 v70, 16, v43
    v_and_b32 v71, 0xffff0000, v43
    v_pk_add_f32 v[72:73], v[72:73], v[64:65]
    v_pk_add_f32 v[74:75], v[74:75], v[66:67]
    v_pk_add_f32 v[76:77], v[76:77], v[68:69]
    v_pk_add_f32 v[78:79], v[78:79], v[70:71]
    s_waitcnt vmcnt(0)
    v_lshlrev_b32 v64, 16, v44
    v_and_b32 v65, 0xffff0000, v44
    v_lshlrev_b32 v66, 16, v45
    v_and_b32 v67, 0xffff0000, v45
    v_lshlrev_b32 v68, 16, v46
    v_and_b32 v69, 0xffff0000, v46
    v_lshlrev_b32 v70, 16, v47
    v_and_b32 v71, 0xffff0000, v47
    v_pk_add_f32 v[72:73], v[72:73], v[64:65]
    v_pk_add_f32 v[74:75], v[74:75], v[66:67]
    v_pk_add_f32 v[76:77], v[76:77], v[68:69]
    v_pk_add_f32 v[78:79], v[78:79], v[70:71]
    ds_write_b128 v53, v[72:75] offset:0
    ds_write_b128 v53, v[76:79] offset:1024
    s_waitcnt lgkmcnt(0)
    s_barrier
L_end:
    s_endpgm
L_compute:
    v_and_b32 v32, 15, v0
    v_lshrrev_b32 v33, 4, v0
    v_bfe_u32 v34, v0, 2, 2
    v_and_b32 v35, 3, v0
    v_lshlrev_b32 v2, 4, v0
    v_and_b32 v36, 1, v33
    v_lshl_or_b32 v36, v36, 2, v34
    v_lshlrev_b32 v38, 3, v35
    v_lshl_or_b32 v38, v36, 5, v38
    v_lshl_add_u32 v37, v33, 3, v34
    v_lshl_add_u32 v10, v37, 8, v38
    v_xor_b32 v11, 32, v10
    v_xor_b32 v12, 64, v10
    v_xor_b32 v13, 96, v10
    v_xor_b32 v14, 128, v10
    v_xor_b32 v15, 160, v10
    v_xor_b32 v16, 192, v10
    v_xor_b32 v17, 224, v10
    v_lshrrev_b32 v36, 1, v32
    v_xor_b32 v36, v36, v33
    v_lshlrev_b32 v36, 4, v36
    v_lshl_add_u32 v36, v32, 7, v36
    s_lshl_b32 s9, s3, 11
    s_add_u32 s9, s9, 49152
    v_add_u32 v18, s9, v36
    v_xor_b32 v19, 64, v18
    v_and_b32 v36, 1, v33
    v_lshrrev_b32 v37, 1, v33
    v_lshl_or_b32 v39, v36, 1, v37
    v_xor_b32 v36, v39, v32
    v_lshlrev_b32 v36, 4, v36
    v_lshl_add_u32 v36, v32, 8, v36
    v_add_u32 v20, 98304, v36
    v_xor_b32 v21, 64, v20
    v_xor_b32 v22, 128, v20
    v_xor_b32 v23, 192, v20
    v_lshl_add_u32 v37, v33, 2, v34
    v_lshl_add_u32 v36, v37, 8, v38
    v_add_u32 v24, 114688, v36
    v_xor_b32 v25, 32, v24
    v_xor_b32 v26, 64, v24
    v_xor_b32 v27, 96, v24
    v_xor_b32 v28, 128, v24
    v_xor_b32 v29, 160, v24
    v_xor_b32 v30, 192, v24
    v_xor_b32 v31, 224, v24
    s_lshl_b32 s9, s3, 6
    v_and_b32 v36, 0xffffffe0, v36
    v_lshl_or_b32 v37, v35, 4, s9
    v_xor_b32 v4, v37, v36
    v_xor_b32 v5, 8, v4
    v_add_u32 v6, 98304, v4
    v_add_u32 v7, 98304, v5
    v_mov_b32 v8, v2
    v_add_u32 v9, 0x10000, v2
    s_xor_b32 s9, s4, s3
    s_xor_b32 s9, s9, 3
    s_and_b32 s9, s9, 3
    s_lshl_b32 s9, s9, 12
    s_add_u32 s9, s9, 65536
    v_add_u32 v3, s9, v2
    s_xor_b32 s9, s4, 7
    v_xor_b32 v36, s9, v0
    v_lshlrev_b32 v36, 10, v36
    v_lshrrev_b32 v37, 2, v0
    v_mul_u32_u24 v37, 80, v37
    v_lshl_add_u32 v37, v0, 2, v37
    v_add_u32 v1, v36, v37
    v_lshlrev_b32 v36, 4, v33
    v_lshl_add_u32 v0, v32, 6, v36
    s_lshl_b32 s10, s7, 6
    s_add_u32 s10, s10, s8
    s_lshl_b32 s10, s10, 2
    s_add_u32 s10, s10, s3
    s_lshl_b32 s10, s10, 12
    s_lshl_b32 s14, s5, 18
    s_lshl_b32 s9, s3, 10
    s_add_u32 s14, s14, s9
    s_xor_b32 s9, s4, 7
    s_lshl_b32 s9, s9, 15
    s_add_u32 s9, s9, s14
    s_add_u32 s36, s9, 8388608
    s_xor_b32 s9, s4, 6
    s_lshl_b32 s9, s9, 15
    s_add_u32 s9, s9, s14
    s_add_u32 s37, s9, 8392704
    s_xor_b32 s9, s4, 5
    s_lshl_b32 s9, s9, 15
    s_add_u32 s9, s9, s14
    s_add_u32 s38, s9, 8396800
    s_xor_b32 s9, s4, 4
    s_lshl_b32 s9, s9, 15
    s_add_u32 s9, s9, s14
    s_add_u32 s39, s9, 8400896
    s_xor_b32 s9, s4, 3
    s_lshl_b32 s9, s9, 15
    s_add_u32 s9, s9, s14
    s_add_u32 s40, s9, 8404992
    s_xor_b32 s9, s4, 2
    s_lshl_b32 s9, s9, 15
    s_add_u32 s9, s9, s14
    s_add_u32 s41, s9, 8409088
    s_xor_b32 s9, s4, 1
    s_lshl_b32 s9, s9, 15
    s_add_u32 s9, s9, s14
    s_add_u32 s42, s9, 8413184
    s_lshl_b32 s13, s7, 5
    s_add_u32 s13, s13, s4
    s_lshl_b32 s13, s13, 2
    s_add_u32 s13, s13, s3
    s_lshl_b32 s13, s13, 6
    s_add_u32 s13, s13, s6
    s_lshl_b32 s13, s13, 2
    s_add_u32 s13, s13, 16777216
    s_lshl_b32 s15, s5, 5
    s_add_u32 s15, s15, s3
    s_lshl_b32 s15, s15, 8
    s_add_u32 s15, s15, 16777248
    s_mov_b32 s11, 0x3e0293ee
    s_waitcnt lgkmcnt(0) vmcnt(0)
    s_mov_b64 s[56:57], s[30:31]
    s_mov_b32 s58, 0x2800000
    s_mov_b32 s59, 0x20000
    s_branch L_pg2
.p2align 12
L_pad2:
    s_branch L_compute
    s_nop 0
L_pg2:
    s_barrier
    ds_read_b128 v[192:195], v18 offset:0
    ds_read_b64_tr_b16 v[128:129], v10 offset:0
    ds_read_b64_tr_b16 v[130:131], v10 offset:1024
    ds_read_b128 v[196:199], v19 offset:0
    ds_read_b64_tr_b16 v[132:133], v10 offset:8192
    ds_read_b64_tr_b16 v[134:135], v10 offset:9216
    ds_read_b128 v[200:203], v18 offset:8192
    ds_read_b128 v[204:207], v19 offset:8192
    ds_read_b64_tr_b16 v[136:137], v11 offset:0
    ds_read_b64_tr_b16 v[138:139], v11 offset:1024
    ds_read_b64_tr_b16 v[140:141], v11 offset:8192
    ds_read_b64_tr_b16 v[142:143], v11 offset:9216
    ds_read_b64_tr_b16 v[144:145], v12 offset:0
    ds_read_b64_tr_b16 v[146:147], v12 offset:1024
    ds_read_b64_tr_b16 v[148:149], v12 offset:8192
    ds_read_b64_tr_b16 v[150:151], v12 offset:9216
    ds_read_b64_tr_b16 v[152:153], v13 offset:0
    ds_read_b64_tr_b16 v[154:155], v13 offset:1024
    ds_read_b64_tr_b16 v[156:157], v13 offset:8192
    ds_read_b64_tr_b16 v[158:159], v13 offset:9216
    s_waitcnt lgkmcnt(12)
    v_mfma_f32_16x16x32_bf16 v[64:67], v[128:131], v[192:195], 0
    v_mfma_f32_16x16x32_bf16 v[64:67], v[132:135], v[196:199], v[64:67]
    v_mfma_f32_16x16x32_bf16 v[68:71], v[128:131], v[200:203], 0
    v_mfma_f32_16x16x32_bf16 v[68:71], v[132:135], v[204:207], v[68:71]
    s_waitcnt lgkmcnt(8)
    v_mfma_f32_16x16x32_bf16 v[72:75], v[136:139], v[192:195], 0
    v_mfma_f32_16x16x32_bf16 v[72:75], v[140:143], v[196:199], v[72:75]
    v_mfma_f32_16x16x32_bf16 v[76:79], v[136:139], v[200:203], 0
    v_mfma_f32_16x16x32_bf16 v[76:79], v[140:143], v[204:207], v[76:79]
    s_waitcnt lgkmcnt(0)
    v_mfma_f32_16x16x32_bf16 v[80:83], v[144:147], v[192:195], 0
    v_mfma_f32_16x16x32_bf16 v[80:83], v[148:151], v[196:199], v[80:83]
    v_mfma_f32_16x16x32_bf16 v[84:87], v[144:147], v[200:203], 0
    v_mfma_f32_16x16x32_bf16 v[84:87], v[148:151], v[204:207], v[84:87]
    v_mfma_f32_16x16x32_bf16 v[88:91], v[152:155], v[192:195], 0
    v_mfma_f32_16x16x32_bf16 v[88:91], v[156:159], v[196:199], v[88:91]
    v_mfma_f32_16x16x32_bf16 v[92:95], v[152:155], v[200:203], 0
    v_mfma_f32_16x16x32_bf16 v[92:95], v[156:159], v[204:207], v[92:95]
    ds_read_b64_tr_b16 v[160:161], v14 offset:0
    ds_read_b64_tr_b16 v[162:163], v14 offset:1024
    ds_read_b64_tr_b16 v[164:165], v14 offset:8192
    ds_read_b64_tr_b16 v[166:167], v14 offset:9216
    ds_read_b64_tr_b16 v[168:169], v15 offset:0
    ds_read_b64_tr_b16 v[170:171], v15 offset:1024
    ds_read_b64_tr_b16 v[172:173], v15 offset:8192
    ds_read_b64_tr_b16 v[174:175], v15 offset:9216
    ds_read_b64_tr_b16 v[176:177], v16 offset:0
    ds_read_b64_tr_b16 v[178:179], v16 offset:1024
    ds_read_b64_tr_b16 v[180:181], v16 offset:8192
    ds_read_b64_tr_b16 v[182:183], v16 offset:9216
    ds_read_b64_tr_b16 v[184:185], v17 offset:0
    ds_read_b64_tr_b16 v[186:187], v17 offset:1024
    ds_read_b64_tr_b16 v[188:189], v17 offset:8192
    ds_read_b64_tr_b16 v[190:191], v17 offset:9216
    s_waitcnt lgkmcnt(0)
    v_mfma_f32_16x16x32_bf16 v[96:99], v[160:163], v[192:195], 0
    v_mfma_f32_16x16x32_bf16 v[96:99], v[164:167], v[196:199], v[96:99]
    v_mfma_f32_16x16x32_bf16 v[100:103], v[160:163], v[200:203], 0
    v_mfma_f32_16x16x32_bf16 v[100:103], v[164:167], v[204:207], v[100:103]
    v_mfma_f32_16x16x32_bf16 v[104:107], v[168:171], v[192:195], 0
    v_mfma_f32_16x16x32_bf16 v[104:107], v[172:175], v[196:199], v[104:107]
    v_mfma_f32_16x16x32_bf16 v[108:111], v[168:171], v[200:203], 0
    v_mfma_f32_16x16x32_bf16 v[108:111], v[172:175], v[204:207], v[108:111]
    v_mfma_f32_16x16x32_bf16 v[112:115], v[176:179], v[192:195], 0
    v_mfma_f32_16x16x32_bf16 v[112:115], v[180:183], v[196:199], v[112:115]
    v_mfma_f32_16x16x32_bf16 v[116:119], v[176:179], v[200:203], 0
    v_mfma_f32_16x16x32_bf16 v[116:119], v[180:183], v[204:207], v[116:119]
    v_mfma_f32_16x16x32_bf16 v[120:123], v[184:187], v[192:195], 0
    v_mfma_f32_16x16x32_bf16 v[120:123], v[188:191], v[196:199], v[120:123]
    v_mfma_f32_16x16x32_bf16 v[124:127], v[184:187], v[200:203], 0
    v_mfma_f32_16x16x32_bf16 v[124:127], v[188:191], v[204:207], v[124:127]
    s_barrier
    ds_read_b128 v[208:211], v18 offset:16384
    ds_read_b64_tr_b16 v[128:129], v10 offset:16384
    ds_read_b64_tr_b16 v[130:131], v10 offset:17408
    ds_read_b128 v[212:215], v19 offset:16384
    ds_read_b64_tr_b16 v[132:133], v10 offset:24576
    ds_read_b64_tr_b16 v[134:135], v10 offset:25600
    ds_read_b128 v[216:219], v18 offset:24576
    ds_read_b128 v[220:223], v19 offset:24576
    ds_read_b64_tr_b16 v[136:137], v11 offset:16384
    ds_read_b64_tr_b16 v[138:139], v11 offset:17408
    ds_read_b64_tr_b16 v[140:141], v11 offset:24576
    ds_read_b64_tr_b16 v[142:143], v11 offset:25600
    ds_read_b64_tr_b16 v[144:145], v12 offset:16384
    ds_read_b64_tr_b16 v[146:147], v12 offset:17408
    ds_read_b64_tr_b16 v[148:149], v12 offset:24576
    ds_read_b64_tr_b16 v[150:151], v12 offset:25600
    ds_read_b64_tr_b16 v[152:153], v13 offset:16384
    ds_read_b64_tr_b16 v[154:155], v13 offset:17408
    ds_read_b64_tr_b16 v[156:157], v13 offset:24576
    ds_read_b64_tr_b16 v[158:159], v13 offset:25600
    s_waitcnt lgkmcnt(12)
    v_mfma_f32_16x16x32_bf16 v[64:67], v[128:131], v[208:211], v[64:67]
    v_mfma_f32_16x16x32_bf16 v[64:67], v[132:135], v[212:215], v[64:67]
    v_mfma_f32_16x16x32_bf16 v[68:71], v[128:131], v[216:219], v[68:71]
    v_mfma_f32_16x16x32_bf16 v[68:71], v[132:135], v[220:223], v[68:71]
    s_waitcnt lgkmcnt(8)
    v_mfma_f32_16x16x32_bf16 v[72:75], v[136:139], v[208:211], v[72:75]
    v_mfma_f32_16x16x32_bf16 v[72:75], v[140:143], v[212:215], v[72:75]
    v_mfma_f32_16x16x32_bf16 v[76:79], v[136:139], v[216:219], v[76:79]
    v_mfma_f32_16x16x32_bf16 v[76:79], v[140:143], v[220:223], v[76:79]
    s_waitcnt lgkmcnt(0)
    v_mfma_f32_16x16x32_bf16 v[80:83], v[144:147], v[208:211], v[80:83]
    v_mfma_f32_16x16x32_bf16 v[80:83], v[148:151], v[212:215], v[80:83]
    v_mfma_f32_16x16x32_bf16 v[84:87], v[144:147], v[216:219], v[84:87]
    v_mfma_f32_16x16x32_bf16 v[84:87], v[148:151], v[220:223], v[84:87]
    v_mfma_f32_16x16x32_bf16 v[88:91], v[152:155], v[208:211], v[88:91]
    v_mfma_f32_16x16x32_bf16 v[88:91], v[156:159], v[212:215], v[88:91]
    v_mfma_f32_16x16x32_bf16 v[92:95], v[152:155], v[216:219], v[92:95]
    v_mfma_f32_16x16x32_bf16 v[92:95], v[156:159], v[220:223], v[92:95]
    ds_read_b64_tr_b16 v[160:161], v14 offset:16384
    ds_read_b64_tr_b16 v[162:163], v14 offset:17408
    ds_read_b64_tr_b16 v[164:165], v14 offset:24576
    ds_read_b64_tr_b16 v[166:167], v14 offset:25600
    ds_read_b64_tr_b16 v[168:169], v15 offset:16384
    ds_read_b64_tr_b16 v[170:171], v15 offset:17408
    ds_read_b64_tr_b16 v[172:173], v15 offset:24576
    ds_read_b64_tr_b16 v[174:175], v15 offset:25600
    ds_read_b64_tr_b16 v[176:177], v16 offset:16384
    ds_read_b64_tr_b16 v[178:179], v16 offset:17408
    ds_read_b64_tr_b16 v[180:181], v16 offset:24576
    ds_read_b64_tr_b16 v[182:183], v16 offset:25600
    ds_read_b64_tr_b16 v[184:185], v17 offset:16384
    ds_read_b64_tr_b16 v[186:187], v17 offset:17408
    ds_read_b64_tr_b16 v[188:189], v17 offset:24576
    ds_read_b64_tr_b16 v[190:191], v17 offset:25600
    s_and_b32 s9, s5, 7
    s_add_u32 s9, s9, 0
    s_xor_b32 s9, s9, s4
    s_or_b32 s9, s9, s3
    s_cbranch_scc1 L_nosig
    s_mov_b64 s[60:61], s[28:29]
    s_mov_b32 s62, 0x100
    s_mov_b32 s63, 0x20000
    v_mov_b32 v62, 1
    s_lshl_b32 s9, s5, 2
    s_mov_b64 exec, 1
    buffer_store_dword v62, v2, s[60:63], s9 offen sc1
    s_mov_b64 exec, -1
L_nosig:
    s_waitcnt lgkmcnt(0)
    v_mfma_f32_16x16x32_bf16 v[96:99], v[160:163], v[208:211], v[96:99]
    v_mfma_f32_16x16x32_bf16 v[96:99], v[164:167], v[212:215], v[96:99]
    v_mfma_f32_16x16x32_bf16 v[100:103], v[160:163], v[216:219], v[100:103]
    v_mfma_f32_16x16x32_bf16 v[100:103], v[164:167], v[220:223], v[100:103]
    v_mfma_f32_16x16x32_bf16 v[104:107], v[168:171], v[208:211], v[104:107]
    v_mfma_f32_16x16x32_bf16 v[104:107], v[172:175], v[212:215], v[104:107]
    v_mfma_f32_16x16x32_bf16 v[108:111], v[168:171], v[216:219], v[108:111]
    v_mfma_f32_16x16x32_bf16 v[108:111], v[172:175], v[220:223], v[108:111]
    v_mfma_f32_16x16x32_bf16 v[112:115], v[176:179], v[208:211], v[112:115]
    v_mfma_f32_16x16x32_bf16 v[112:115], v[180:183], v[212:215], v[112:115]
    v_mfma_f32_16x16x32_bf16 v[116:119], v[176:179], v[216:219], v[116:119]
    v_mfma_f32_16x16x32_bf16 v[116:119], v[180:183], v[220:223], v[116:119]
    v_mfma_f32_16x16x32_bf16 v[120:123], v[184:187], v[208:211], v[120:123]
    v_mfma_f32_16x16x32_bf16 v[120:123], v[188:191], v[212:215], v[120:123]
    v_mfma_f32_16x16x32_bf16 v[124:127], v[184:187], v[216:219], v[124:127]
    v_mfma_f32_16x16x32_bf16 v[124:127], v[188:191], v[220:223], v[124:127]
    s_barrier
    ds_read_b128 v[192:195], v18 offset:32768
    ds_read_b64_tr_b16 v[128:129], v10 offset:32768
    ds_read_b64_tr_b16 v[130:131], v10 offset:33792
    ds_read_b128 v[196:199], v19 offset:32768
    ds_read_b64_tr_b16 v[132:133], v10 offset:40960
    ds_read_b64_tr_b16 v[134:135], v10 offset:41984
    ds_read_b128 v[200:203], v18 offset:40960
    ds_read_b128 v[204:207], v19 offset:40960
    ds_read_b64_tr_b16 v[136:137], v11 offset:32768
    ds_read_b64_tr_b16 v[138:139], v11 offset:33792
    ds_read_b64_tr_b16 v[140:141], v11 offset:40960
    ds_read_b64_tr_b16 v[142:143], v11 offset:41984
    ds_read_b64_tr_b16 v[144:145], v12 offset:32768
    ds_read_b64_tr_b16 v[146:147], v12 offset:33792
    ds_read_b64_tr_b16 v[148:149], v12 offset:40960
    ds_read_b64_tr_b16 v[150:151], v12 offset:41984
    ds_read_b64_tr_b16 v[152:153], v13 offset:32768
    ds_read_b64_tr_b16 v[154:155], v13 offset:33792
    ds_read_b64_tr_b16 v[156:157], v13 offset:40960
    ds_read_b64_tr_b16 v[158:159], v13 offset:41984
    s_waitcnt lgkmcnt(12)
    v_mfma_f32_16x16x32_bf16 v[64:67], v[128:131], v[192:195], v[64:67]
    v_mfma_f32_16x16x32_bf16 v[64:67], v[132:135], v[196:199], v[64:67]
    v_mfma_f32_16x16x32_bf16 v[68:71], v[128:131], v[200:203], v[68:71]
    v_mfma_f32_16x16x32_bf16 v[68:71], v[132:135], v[204:207], v[68:71]
    s_waitcnt lgkmcnt(8)
    v_mfma_f32_16x16x32_bf16 v[72:75], v[136:139], v[192:195], v[72:75]
    v_mfma_f32_16x16x32_bf16 v[72:75], v[140:143], v[196:199], v[72:75]
    v_mfma_f32_16x16x32_bf16 v[76:79], v[136:139], v[200:203], v[76:79]
    v_mfma_f32_16x16x32_bf16 v[76:79], v[140:143], v[204:207], v[76:79]
    s_waitcnt lgkmcnt(0)
    v_mfma_f32_16x16x32_bf16 v[80:83], v[144:147], v[192:195], v[80:83]
    v_mfma_f32_16x16x32_bf16 v[80:83], v[148:151], v[196:199], v[80:83]
    v_mfma_f32_16x16x32_bf16 v[84:87], v[144:147], v[200:203], v[84:87]
    v_mfma_f32_16x16x32_bf16 v[84:87], v[148:151], v[204:207], v[84:87]
    v_mfma_f32_16x16x32_bf16 v[88:91], v[152:155], v[192:195], v[88:91]
    v_mfma_f32_16x16x32_bf16 v[88:91], v[156:159], v[196:199], v[88:91]
    v_mfma_f32_16x16x32_bf16 v[92:95], v[152:155], v[200:203], v[92:95]
    v_mfma_f32_16x16x32_bf16 v[92:95], v[156:159], v[204:207], v[92:95]
    ds_read_b64_tr_b16 v[160:161], v14 offset:32768
    ds_read_b64_tr_b16 v[162:163], v14 offset:33792
    ds_read_b64_tr_b16 v[164:165], v14 offset:40960
    ds_read_b64_tr_b16 v[166:167], v14 offset:41984
    ds_read_b64_tr_b16 v[168:169], v15 offset:32768
    ds_read_b64_tr_b16 v[170:171], v15 offset:33792
    ds_read_b64_tr_b16 v[172:173], v15 offset:40960
    ds_read_b64_tr_b16 v[174:175], v15 offset:41984
    ds_read_b64_tr_b16 v[176:177], v16 offset:32768
    ds_read_b64_tr_b16 v[178:179], v16 offset:33792
    ds_read_b64_tr_b16 v[180:181], v16 offset:40960
    ds_read_b64_tr_b16 v[182:183], v16 offset:41984
    ds_read_b64_tr_b16 v[184:185], v17 offset:32768
    ds_read_b64_tr_b16 v[186:187], v17 offset:33792
    ds_read_b64_tr_b16 v[188:189], v17 offset:40960
    ds_read_b64_tr_b16 v[190:191], v17 offset:41984
    s_waitcnt lgkmcnt(0)
    s_barrier
    v_mfma_f32_16x16x32_bf16 v[96:99], v[160:163], v[192:195], v[96:99]
    v_mfma_f32_16x16x32_bf16 v[96:99], v[164:167], v[196:199], v[96:99]
    v_mfma_f32_16x16x32_bf16 v[100:103], v[160:163], v[200:203], v[100:103]
    v_mfma_f32_16x16x32_bf16 v[100:103], v[164:167], v[204:207], v[100:103]
    v_mfma_f32_16x16x32_bf16 v[104:107], v[168:171], v[192:195], v[104:107]
    v_mfma_f32_16x16x32_bf16 v[104:107], v[172:175], v[196:199], v[104:107]
    v_mfma_f32_16x16x32_bf16 v[108:111], v[168:171], v[200:203], v[108:111]
    v_mfma_f32_16x16x32_bf16 v[108:111], v[172:175], v[204:207], v[108:111]
    v_mfma_f32_16x16x32_bf16 v[112:115], v[176:179], v[192:195], v[112:115]
    v_mfma_f32_16x16x32_bf16 v[112:115], v[180:183], v[196:199], v[112:115]
    v_mfma_f32_16x16x32_bf16 v[116:119], v[176:179], v[200:203], v[116:119]
    v_mfma_f32_16x16x32_bf16 v[116:119], v[180:183], v[204:207], v[116:119]
    v_mfma_f32_16x16x32_bf16 v[120:123], v[184:187], v[192:195], v[120:123]
    v_mfma_f32_16x16x32_bf16 v[120:123], v[188:191], v[196:199], v[120:123]
    v_mfma_f32_16x16x32_bf16 v[124:127], v[184:187], v[200:203], v[124:127]
    v_mfma_f32_16x16x32_bf16 v[124:127], v[188:191], v[204:207], v[124:127]
    ds_read_b128 v[208:211], v18 offset:0
    ds_read_b64_tr_b16 v[128:129], v10 offset:0
    ds_read_b64_tr_b16 v[130:131], v10 offset:1024
    ds_read_b128 v[212:215], v19 offset:0
    ds_read_b64_tr_b16 v[132:133], v10 offset:8192
    ds_read_b64_tr_b16 v[134:135], v10 offset:9216
    ds_read_b128 v[216:219], v18 offset:8192
    ds_read_b128 v[220:223], v19 offset:8192
    ds_read_b64_tr_b16 v[136:137], v11 offset:0
    ds_read_b64_tr_b16 v[138:139], v11 offset:1024
    ds_read_b64_tr_b16 v[140:141], v11 offset:8192
    ds_read_b64_tr_b16 v[142:143], v11 offset:9216
    ds_read_b64_tr_b16 v[144:145], v12 offset:0
    ds_read_b64_tr_b16 v[146:147], v12 offset:1024
    ds_read_b64_tr_b16 v[148:149], v12 offset:8192
    ds_read_b64_tr_b16 v[150:151], v12 offset:9216
    ds_read_b64_tr_b16 v[152:153], v13 offset:0
    ds_read_b64_tr_b16 v[154:155], v13 offset:1024
    ds_read_b64_tr_b16 v[156:157], v13 offset:8192
    ds_read_b64_tr_b16 v[158:159], v13 offset:9216
    s_waitcnt lgkmcnt(12)
    v_mfma_f32_16x16x32_bf16 v[64:67], v[128:131], v[208:211], v[64:67]
    v_mfma_f32_16x16x32_bf16 v[64:67], v[132:135], v[212:215], v[64:67]
    v_mfma_f32_16x16x32_bf16 v[68:71], v[128:131], v[216:219], v[68:71]
    v_mfma_f32_16x16x32_bf16 v[68:71], v[132:135], v[220:223], v[68:71]
    s_waitcnt lgkmcnt(8)
    v_mfma_f32_16x16x32_bf16 v[72:75], v[136:139], v[208:211], v[72:75]
    v_mfma_f32_16x16x32_bf16 v[72:75], v[140:143], v[212:215], v[72:75]
    v_mfma_f32_16x16x32_bf16 v[76:79], v[136:139], v[216:219], v[76:79]
    v_mfma_f32_16x16x32_bf16 v[76:79], v[140:143], v[220:223], v[76:79]
    s_waitcnt lgkmcnt(0)
    v_mfma_f32_16x16x32_bf16 v[80:83], v[144:147], v[208:211], v[80:83]
    v_mfma_f32_16x16x32_bf16 v[80:83], v[148:151], v[212:215], v[80:83]
    v_mfma_f32_16x16x32_bf16 v[84:87], v[144:147], v[216:219], v[84:87]
    v_mfma_f32_16x16x32_bf16 v[84:87], v[148:151], v[220:223], v[84:87]
    v_mfma_f32_16x16x32_bf16 v[88:91], v[152:155], v[208:211], v[88:91]
    v_mfma_f32_16x16x32_bf16 v[88:91], v[156:159], v[212:215], v[88:91]
    v_mfma_f32_16x16x32_bf16 v[92:95], v[152:155], v[216:219], v[92:95]
    v_mfma_f32_16x16x32_bf16 v[92:95], v[156:159], v[220:223], v[92:95]
    ds_read_b64_tr_b16 v[160:161], v14 offset:0
    ds_read_b64_tr_b16 v[162:163], v14 offset:1024
    ds_read_b64_tr_b16 v[164:165], v14 offset:8192
    ds_read_b64_tr_b16 v[166:167], v14 offset:9216
    ds_read_b64_tr_b16 v[168:169], v15 offset:0
    ds_read_b64_tr_b16 v[170:171], v15 offset:1024
    ds_read_b64_tr_b16 v[172:173], v15 offset:8192
    ds_read_b64_tr_b16 v[174:175], v15 offset:9216
    ds_read_b64_tr_b16 v[176:177], v16 offset:0
    ds_read_b64_tr_b16 v[178:179], v16 offset:1024
    ds_read_b64_tr_b16 v[180:181], v16 offset:8192
    ds_read_b64_tr_b16 v[182:183], v16 offset:9216
    ds_read_b64_tr_b16 v[184:185], v17 offset:0
    ds_read_b64_tr_b16 v[186:187], v17 offset:1024
    ds_read_b64_tr_b16 v[188:189], v17 offset:8192
    ds_read_b64_tr_b16 v[190:191], v17 offset:9216
    s_waitcnt lgkmcnt(0)
    s_barrier
    v_mfma_f32_16x16x32_bf16 v[96:99], v[160:163], v[208:211], v[96:99]
    ds_read_b128 v[192:195], v18 offset:16384
    ds_read_b64_tr_b16 v[128:129], v10 offset:16384
    v_mfma_f32_16x16x32_bf16 v[96:99], v[164:167], v[212:215], v[96:99]
    ds_read_b64_tr_b16 v[130:131], v10 offset:17408
    ds_read_b128 v[196:199], v19 offset:16384
    v_mfma_f32_16x16x32_bf16 v[100:103], v[160:163], v[216:219], v[100:103]
    ds_read_b64_tr_b16 v[132:133], v10 offset:24576
    ds_read_b64_tr_b16 v[134:135], v10 offset:25600
    v_mfma_f32_16x16x32_bf16 v[100:103], v[164:167], v[220:223], v[100:103]
    ds_read_b128 v[200:203], v18 offset:24576
    ds_read_b128 v[204:207], v19 offset:24576
    v_mfma_f32_16x16x32_bf16 v[104:107], v[168:171], v[208:211], v[104:107]
    ds_read_b64_tr_b16 v[136:137], v11 offset:16384
    v_mfma_f32_16x16x32_bf16 v[104:107], v[172:175], v[212:215], v[104:107]
    ds_read_b64_tr_b16 v[138:139], v11 offset:17408
    v_mfma_f32_16x16x32_bf16 v[108:111], v[168:171], v[216:219], v[108:111]
    ds_read_b64_tr_b16 v[140:141], v11 offset:24576
    v_mfma_f32_16x16x32_bf16 v[108:111], v[172:175], v[220:223], v[108:111]
    ds_read_b64_tr_b16 v[142:143], v11 offset:25600
    v_mfma_f32_16x16x32_bf16 v[112:115], v[176:179], v[208:211], v[112:115]
    ds_read_b64_tr_b16 v[144:145], v12 offset:16384
    v_mfma_f32_16x16x32_bf16 v[112:115], v[180:183], v[212:215], v[112:115]
    ds_read_b64_tr_b16 v[146:147], v12 offset:17408
    v_mfma_f32_16x16x32_bf16 v[116:119], v[176:179], v[216:219], v[116:119]
    ds_read_b64_tr_b16 v[148:149], v12 offset:24576
    v_mfma_f32_16x16x32_bf16 v[116:119], v[180:183], v[220:223], v[116:119]
    ds_read_b64_tr_b16 v[150:151], v12 offset:25600
    v_mfma_f32_16x16x32_bf16 v[120:123], v[184:187], v[208:211], v[120:123]
    ds_read_b64_tr_b16 v[152:153], v13 offset:16384
    v_mfma_f32_16x16x32_bf16 v[120:123], v[188:191], v[212:215], v[120:123]
    ds_read_b64_tr_b16 v[154:155], v13 offset:17408
    v_mfma_f32_16x16x32_bf16 v[124:127], v[184:187], v[216:219], v[124:127]
    ds_read_b64_tr_b16 v[156:157], v13 offset:24576
    v_mfma_f32_16x16x32_bf16 v[124:127], v[188:191], v[220:223], v[124:127]
    ds_read_b64_tr_b16 v[158:159], v13 offset:25600
    s_waitcnt lgkmcnt(12)
    v_mfma_f32_16x16x32_bf16 v[64:67], v[128:131], v[192:195], v[64:67]
    ds_read_b64_tr_b16 v[160:161], v14 offset:16384
    ds_read_b64_tr_b16 v[162:163], v14 offset:17408
    v_mfma_f32_16x16x32_bf16 v[64:67], v[132:135], v[196:199], v[64:67]
    ds_read_b64_tr_b16 v[164:165], v14 offset:24576
    ds_read_b64_tr_b16 v[166:167], v14 offset:25600
    v_mfma_f32_16x16x32_bf16 v[68:71], v[128:131], v[200:203], v[68:71]
    ds_read_b64_tr_b16 v[168:169], v15 offset:16384
    ds_read_b64_tr_b16 v[170:171], v15 offset:17408
    v_mfma_f32_16x16x32_bf16 v[68:71], v[132:135], v[204:207], v[68:71]
    ds_read_b64_tr_b16 v[172:173], v15 offset:24576
    ds_read_b64_tr_b16 v[174:175], v15 offset:25600
    s_waitcnt lgkmcnt(14)
    v_mfma_f32_16x16x32_bf16 v[72:75], v[136:139], v[192:195], v[72:75]
    ds_read_b64_tr_b16 v[176:177], v16 offset:16384
    v_mfma_f32_16x16x32_bf16 v[72:75], v[140:143], v[196:199], v[72:75]
    ds_read_b64_tr_b16 v[178:179], v16 offset:17408
    v_mfma_f32_16x16x32_bf16 v[76:79], v[136:139], v[200:203], v[76:79]
    ds_read_b64_tr_b16 v[180:181], v16 offset:24576
    v_mfma_f32_16x16x32_bf16 v[76:79], v[140:143], v[204:207], v[76:79]
    ds_read_b64_tr_b16 v[182:183], v16 offset:25600
    s_waitcnt lgkmcnt(12)
    v_mfma_f32_16x16x32_bf16 v[80:83], v[144:147], v[192:195], v[80:83]
    ds_read_b64_tr_b16 v[184:185], v17 offset:16384
    v_mfma_f32_16x16x32_bf16 v[80:83], v[148:151], v[196:199], v[80:83]
    ds_read_b64_tr_b16 v[186:187], v17 offset:17408
    v_mfma_f32_16x16x32_bf16 v[84:87], v[144:147], v[200:203], v[84:87]
    ds_read_b64_tr_b16 v[188:189], v17 offset:24576
    v_mfma_f32_16x16x32_bf16 v[84:87], v[148:151], v[204:207], v[84:87]
    ds_read_b64_tr_b16 v[190:191], v17 offset:25600
    v_mfma_f32_16x16x32_bf16 v[88:91], v[152:155], v[192:195], v[88:91]
    v_mfma_f32_16x16x32_bf16 v[88:91], v[156:159], v[196:199], v[88:91]
    v_mfma_f32_16x16x32_bf16 v[92:95], v[152:155], v[200:203], v[92:95]
    v_mfma_f32_16x16x32_bf16 v[92:95], v[156:159], v[204:207], v[92:95]
    s_waitcnt lgkmcnt(0)
    s_barrier
    v_mfma_f32_16x16x32_bf16 v[96:99], v[160:163], v[192:195], v[96:99]
    ds_read_b128 v[208:211], v18 offset:32768
    ds_read_b64_tr_b16 v[128:129], v10 offset:32768
    v_mfma_f32_16x16x32_bf16 v[96:99], v[164:167], v[196:199], v[96:99]
    ds_read_b64_tr_b16 v[130:131], v10 offset:33792
    ds_read_b128 v[212:215], v19 offset:32768
    v_mfma_f32_16x16x32_bf16 v[100:103], v[160:163], v[200:203], v[100:103]
    ds_read_b64_tr_b16 v[132:133], v10 offset:40960
    ds_read_b64_tr_b16 v[134:135], v10 offset:41984
    v_mfma_f32_16x16x32_bf16 v[100:103], v[164:167], v[204:207], v[100:103]
    ds_read_b128 v[216:219], v18 offset:40960
    ds_read_b128 v[220:223], v19 offset:40960
    v_mfma_f32_16x16x32_bf16 v[104:107], v[168:171], v[192:195], v[104:107]
    ds_read_b64_tr_b16 v[136:137], v11 offset:32768
    v_mfma_f32_16x16x32_bf16 v[104:107], v[172:175], v[196:199], v[104:107]
    ds_read_b64_tr_b16 v[138:139], v11 offset:33792
    v_mfma_f32_16x16x32_bf16 v[108:111], v[168:171], v[200:203], v[108:111]
    ds_read_b64_tr_b16 v[140:141], v11 offset:40960
    v_mfma_f32_16x16x32_bf16 v[108:111], v[172:175], v[204:207], v[108:111]
    ds_read_b64_tr_b16 v[142:143], v11 offset:41984
    v_mfma_f32_16x16x32_bf16 v[112:115], v[176:179], v[192:195], v[112:115]
    ds_read_b64_tr_b16 v[144:145], v12 offset:32768
    v_mfma_f32_16x16x32_bf16 v[112:115], v[180:183], v[196:199], v[112:115]
    ds_read_b64_tr_b16 v[146:147], v12 offset:33792
    v_mfma_f32_16x16x32_bf16 v[116:119], v[176:179], v[200:203], v[116:119]
    ds_read_b64_tr_b16 v[148:149], v12 offset:40960
    v_mfma_f32_16x16x32_bf16 v[116:119], v[180:183], v[204:207], v[116:119]
    ds_read_b64_tr_b16 v[150:151], v12 offset:41984
    v_mfma_f32_16x16x32_bf16 v[120:123], v[184:187], v[192:195], v[120:123]
    ds_read_b64_tr_b16 v[152:153], v13 offset:32768
    v_mfma_f32_16x16x32_bf16 v[120:123], v[188:191], v[196:199], v[120:123]
    ds_read_b64_tr_b16 v[154:155], v13 offset:33792
    v_mfma_f32_16x16x32_bf16 v[124:127], v[184:187], v[200:203], v[124:127]
    ds_read_b64_tr_b16 v[156:157], v13 offset:40960
    v_mfma_f32_16x16x32_bf16 v[124:127], v[188:191], v[204:207], v[124:127]
    ds_read_b64_tr_b16 v[158:159], v13 offset:41984
    s_waitcnt lgkmcnt(12)
    v_mfma_f32_16x16x32_bf16 v[64:67], v[128:131], v[208:211], v[64:67]
    ds_read_b64_tr_b16 v[160:161], v14 offset:32768
    ds_read_b64_tr_b16 v[162:163], v14 offset:33792
    v_mfma_f32_16x16x32_bf16 v[64:67], v[132:135], v[212:215], v[64:67]
    ds_read_b64_tr_b16 v[164:165], v14 offset:40960
    ds_read_b64_tr_b16 v[166:167], v14 offset:41984
    v_mfma_f32_16x16x32_bf16 v[68:71], v[128:131], v[216:219], v[68:71]
    ds_read_b64_tr_b16 v[168:169], v15 offset:32768
    ds_read_b64_tr_b16 v[170:171], v15 offset:33792
    v_mfma_f32_16x16x32_bf16 v[68:71], v[132:135], v[220:223], v[68:71]
    ds_read_b64_tr_b16 v[172:173], v15 offset:40960
    ds_read_b64_tr_b16 v[174:175], v15 offset:41984
    s_waitcnt lgkmcnt(14)
    v_mfma_f32_16x16x32_bf16 v[72:75], v[136:139], v[208:211], v[72:75]
    ds_read_b64_tr_b16 v[176:177], v16 offset:32768
    v_mfma_f32_16x16x32_bf16 v[72:75], v[140:143], v[212:215], v[72:75]
    ds_read_b64_tr_b16 v[178:179], v16 offset:33792
    v_mfma_f32_16x16x32_bf16 v[76:79], v[136:139], v[216:219], v[76:79]
    ds_read_b64_tr_b16 v[180:181], v16 offset:40960
    v_mfma_f32_16x16x32_bf16 v[76:79], v[140:143], v[220:223], v[76:79]
    ds_read_b64_tr_b16 v[182:183], v16 offset:41984
    s_waitcnt lgkmcnt(12)
    v_mfma_f32_16x16x32_bf16 v[80:83], v[144:147], v[208:211], v[80:83]
    ds_read_b64_tr_b16 v[184:185], v17 offset:32768
    v_mfma_f32_16x16x32_bf16 v[80:83], v[148:151], v[212:215], v[80:83]
    ds_read_b64_tr_b16 v[186:187], v17 offset:33792
    v_mfma_f32_16x16x32_bf16 v[84:87], v[144:147], v[216:219], v[84:87]
    ds_read_b64_tr_b16 v[188:189], v17 offset:40960
    v_mfma_f32_16x16x32_bf16 v[84:87], v[148:151], v[220:223], v[84:87]
    ds_read_b64_tr_b16 v[190:191], v17 offset:41984
    v_mfma_f32_16x16x32_bf16 v[88:91], v[152:155], v[208:211], v[88:91]
    v_mfma_f32_16x16x32_bf16 v[88:91], v[156:159], v[212:215], v[88:91]
    v_mfma_f32_16x16x32_bf16 v[92:95], v[152:155], v[216:219], v[92:95]
    v_mfma_f32_16x16x32_bf16 v[92:95], v[156:159], v[220:223], v[92:95]
    s_waitcnt lgkmcnt(0)
    s_barrier
    v_mfma_f32_16x16x32_bf16 v[96:99], v[160:163], v[208:211], v[96:99]
    ds_read_b128 v[192:195], v18 offset:0
    ds_read_b64_tr_b16 v[128:129], v10 offset:0
    v_mfma_f32_16x16x32_bf16 v[96:99], v[164:167], v[212:215], v[96:99]
    ds_read_b64_tr_b16 v[130:131], v10 offset:1024
    ds_read_b128 v[196:199], v19 offset:0
    v_mfma_f32_16x16x32_bf16 v[100:103], v[160:163], v[216:219], v[100:103]
    ds_read_b64_tr_b16 v[132:133], v10 offset:8192
    ds_read_b64_tr_b16 v[134:135], v10 offset:9216
    v_mfma_f32_16x16x32_bf16 v[100:103], v[164:167], v[220:223], v[100:103]
    ds_read_b128 v[200:203], v18 offset:8192
    ds_read_b128 v[204:207], v19 offset:8192
    v_mfma_f32_16x16x32_bf16 v[104:107], v[168:171], v[208:211], v[104:107]
    ds_read_b64_tr_b16 v[136:137], v11 offset:0
    v_mfma_f32_16x16x32_bf16 v[104:107], v[172:175], v[212:215], v[104:107]
    ds_read_b64_tr_b16 v[138:139], v11 offset:1024
    v_mfma_f32_16x16x32_bf16 v[108:111], v[168:171], v[216:219], v[108:111]
    ds_read_b64_tr_b16 v[140:141], v11 offset:8192
    v_mfma_f32_16x16x32_bf16 v[108:111], v[172:175], v[220:223], v[108:111]
    ds_read_b64_tr_b16 v[142:143], v11 offset:9216
    v_mfma_f32_16x16x32_bf16 v[112:115], v[176:179], v[208:211], v[112:115]
    ds_read_b64_tr_b16 v[144:145], v12 offset:0
    v_mfma_f32_16x16x32_bf16 v[112:115], v[180:183], v[212:215], v[112:115]
    ds_read_b64_tr_b16 v[146:147], v12 offset:1024
    v_mfma_f32_16x16x32_bf16 v[116:119], v[176:179], v[216:219], v[116:119]
    ds_read_b64_tr_b16 v[148:149], v12 offset:8192
    v_mfma_f32_16x16x32_bf16 v[116:119], v[180:183], v[220:223], v[116:119]
    ds_read_b64_tr_b16 v[150:151], v12 offset:9216
    v_mfma_f32_16x16x32_bf16 v[120:123], v[184:187], v[208:211], v[120:123]
    ds_read_b64_tr_b16 v[152:153], v13 offset:0
    v_mfma_f32_16x16x32_bf16 v[120:123], v[188:191], v[212:215], v[120:123]
    ds_read_b64_tr_b16 v[154:155], v13 offset:1024
    v_mfma_f32_16x16x32_bf16 v[124:127], v[184:187], v[216:219], v[124:127]
    ds_read_b64_tr_b16 v[156:157], v13 offset:8192
    v_mfma_f32_16x16x32_bf16 v[124:127], v[188:191], v[220:223], v[124:127]
    ds_read_b64_tr_b16 v[158:159], v13 offset:9216
    s_waitcnt lgkmcnt(12)
    v_mfma_f32_16x16x32_bf16 v[64:67], v[128:131], v[192:195], v[64:67]
    ds_read_b64_tr_b16 v[160:161], v14 offset:0
    ds_read_b64_tr_b16 v[162:163], v14 offset:1024
    v_mfma_f32_16x16x32_bf16 v[64:67], v[132:135], v[196:199], v[64:67]
    ds_read_b64_tr_b16 v[164:165], v14 offset:8192
    ds_read_b64_tr_b16 v[166:167], v14 offset:9216
    v_mfma_f32_16x16x32_bf16 v[68:71], v[128:131], v[200:203], v[68:71]
    ds_read_b64_tr_b16 v[168:169], v15 offset:0
    ds_read_b64_tr_b16 v[170:171], v15 offset:1024
    v_mfma_f32_16x16x32_bf16 v[68:71], v[132:135], v[204:207], v[68:71]
    ds_read_b64_tr_b16 v[172:173], v15 offset:8192
    ds_read_b64_tr_b16 v[174:175], v15 offset:9216
    s_waitcnt lgkmcnt(14)
    v_mfma_f32_16x16x32_bf16 v[72:75], v[136:139], v[192:195], v[72:75]
    ds_read_b64_tr_b16 v[176:177], v16 offset:0
    v_mfma_f32_16x16x32_bf16 v[72:75], v[140:143], v[196:199], v[72:75]
    ds_read_b64_tr_b16 v[178:179], v16 offset:1024
    v_mfma_f32_16x16x32_bf16 v[76:79], v[136:139], v[200:203], v[76:79]
    ds_read_b64_tr_b16 v[180:181], v16 offset:8192
    v_mfma_f32_16x16x32_bf16 v[76:79], v[140:143], v[204:207], v[76:79]
    ds_read_b64_tr_b16 v[182:183], v16 offset:9216
    s_waitcnt lgkmcnt(12)
    v_mfma_f32_16x16x32_bf16 v[80:83], v[144:147], v[192:195], v[80:83]
    ds_read_b64_tr_b16 v[184:185], v17 offset:0
    v_mfma_f32_16x16x32_bf16 v[80:83], v[148:151], v[196:199], v[80:83]
    ds_read_b64_tr_b16 v[186:187], v17 offset:1024
    v_mfma_f32_16x16x32_bf16 v[84:87], v[144:147], v[200:203], v[84:87]
    ds_read_b64_tr_b16 v[188:189], v17 offset:8192
    v_mfma_f32_16x16x32_bf16 v[84:87], v[148:151], v[204:207], v[84:87]
    ds_read_b64_tr_b16 v[190:191], v17 offset:9216
    v_mfma_f32_16x16x32_bf16 v[88:91], v[152:155], v[192:195], v[88:91]
    v_mfma_f32_16x16x32_bf16 v[88:91], v[156:159], v[196:199], v[88:91]
    v_mfma_f32_16x16x32_bf16 v[92:95], v[152:155], v[200:203], v[92:95]
    v_mfma_f32_16x16x32_bf16 v[92:95], v[156:159], v[204:207], v[92:95]
    s_waitcnt lgkmcnt(0)
    s_branch L_pg3
.p2align 12
L_pad3:
    s_branch L_compute
    s_nop 0
L_pg3:
    s_barrier
    v_mfma_f32_16x16x32_bf16 v[96:99], v[160:163], v[192:195], v[96:99]
    ds_read_b128 v[208:211], v18 offset:16384
    ds_read_b64_tr_b16 v[128:129], v10 offset:16384
    v_mfma_f32_16x16x32_bf16 v[96:99], v[164:167], v[196:199], v[96:99]
    ds_read_b64_tr_b16 v[130:131], v10 offset:17408
    ds_read_b128 v[212:215], v19 offset:16384
    v_mfma_f32_16x16x32_bf16 v[100:103], v[160:163], v[200:203], v[100:103]
    ds_read_b64_tr_b16 v[132:133], v10 offset:24576
    ds_read_b64_tr_b16 v[134:135], v10 offset:25600
    v_mfma_f32_16x16x32_bf16 v[100:103], v[164:167], v[204:207], v[100:103]
    ds_read_b128 v[216:219], v18 offset:24576
    ds_read_b128 v[220:223], v19 offset:24576
    v_mfma_f32_16x16x32_bf16 v[104:107], v[168:171], v[192:195], v[104:107]
    ds_read_b64_tr_b16 v[136:137], v11 offset:16384
    v_mfma_f32_16x16x32_bf16 v[104:107], v[172:175], v[196:199], v[104:107]
    ds_read_b64_tr_b16 v[138:139], v11 offset:17408
    v_mfma_f32_16x16x32_bf16 v[108:111], v[168:171], v[200:203], v[108:111]
    ds_read_b64_tr_b16 v[140:141], v11 offset:24576
    v_mfma_f32_16x16x32_bf16 v[108:111], v[172:175], v[204:207], v[108:111]
    ds_read_b64_tr_b16 v[142:143], v11 offset:25600
    v_mfma_f32_16x16x32_bf16 v[112:115], v[176:179], v[192:195], v[112:115]
    ds_read_b64_tr_b16 v[144:145], v12 offset:16384
    v_mfma_f32_16x16x32_bf16 v[112:115], v[180:183], v[196:199], v[112:115]
    ds_read_b64_tr_b16 v[146:147], v12 offset:17408
    v_mfma_f32_16x16x32_bf16 v[116:119], v[176:179], v[200:203], v[116:119]
    ds_read_b64_tr_b16 v[148:149], v12 offset:24576
    v_mfma_f32_16x16x32_bf16 v[116:119], v[180:183], v[204:207], v[116:119]
    ds_read_b64_tr_b16 v[150:151], v12 offset:25600
    v_mfma_f32_16x16x32_bf16 v[120:123], v[184:187], v[192:195], v[120:123]
    ds_read_b64_tr_b16 v[152:153], v13 offset:16384
    v_mfma_f32_16x16x32_bf16 v[120:123], v[188:191], v[196:199], v[120:123]
    ds_read_b64_tr_b16 v[154:155], v13 offset:17408
    v_mfma_f32_16x16x32_bf16 v[124:127], v[184:187], v[200:203], v[124:127]
    ds_read_b64_tr_b16 v[156:157], v13 offset:24576
    v_mfma_f32_16x16x32_bf16 v[124:127], v[188:191], v[204:207], v[124:127]
    ds_read_b64_tr_b16 v[158:159], v13 offset:25600
    s_waitcnt lgkmcnt(12)
    v_mfma_f32_16x16x32_bf16 v[64:67], v[128:131], v[208:211], v[64:67]
    ds_read_b64_tr_b16 v[160:161], v14 offset:16384
    ds_read_b64_tr_b16 v[162:163], v14 offset:17408
    v_mfma_f32_16x16x32_bf16 v[64:67], v[132:135], v[212:215], v[64:67]
    ds_read_b64_tr_b16 v[164:165], v14 offset:24576
    ds_read_b64_tr_b16 v[166:167], v14 offset:25600
    v_mfma_f32_16x16x32_bf16 v[68:71], v[128:131], v[216:219], v[68:71]
    ds_read_b64_tr_b16 v[168:169], v15 offset:16384
    ds_read_b64_tr_b16 v[170:171], v15 offset:17408
    v_mfma_f32_16x16x32_bf16 v[68:71], v[132:135], v[220:223], v[68:71]
    ds_read_b64_tr_b16 v[172:173], v15 offset:24576
    ds_read_b64_tr_b16 v[174:175], v15 offset:25600
    s_waitcnt lgkmcnt(14)
    v_mfma_f32_16x16x32_bf16 v[72:75], v[136:139], v[208:211], v[72:75]
    ds_read_b64_tr_b16 v[176:177], v16 offset:16384
    v_mfma_f32_16x16x32_bf16 v[72:75], v[140:143], v[212:215], v[72:75]
    ds_read_b64_tr_b16 v[178:179], v16 offset:17408
    v_mfma_f32_16x16x32_bf16 v[76:79], v[136:139], v[216:219], v[76:79]
    ds_read_b64_tr_b16 v[180:181], v16 offset:24576
    v_mfma_f32_16x16x32_bf16 v[76:79], v[140:143], v[220:223], v[76:79]
    ds_read_b64_tr_b16 v[182:183], v16 offset:25600
    s_waitcnt lgkmcnt(12)
    v_mfma_f32_16x16x32_bf16 v[80:83], v[144:147], v[208:211], v[80:83]
    ds_read_b64_tr_b16 v[184:185], v17 offset:16384
    v_mfma_f32_16x16x32_bf16 v[80:83], v[148:151], v[212:215], v[80:83]
    ds_read_b64_tr_b16 v[186:187], v17 offset:17408
    v_mfma_f32_16x16x32_bf16 v[84:87], v[144:147], v[216:219], v[84:87]
    ds_read_b64_tr_b16 v[188:189], v17 offset:24576
    v_mfma_f32_16x16x32_bf16 v[84:87], v[148:151], v[220:223], v[84:87]
    ds_read_b64_tr_b16 v[190:191], v17 offset:25600
    v_mfma_f32_16x16x32_bf16 v[88:91], v[152:155], v[208:211], v[88:91]
    v_mfma_f32_16x16x32_bf16 v[88:91], v[156:159], v[212:215], v[88:91]
    v_mfma_f32_16x16x32_bf16 v[92:95], v[152:155], v[216:219], v[92:95]
    v_mfma_f32_16x16x32_bf16 v[92:95], v[156:159], v[220:223], v[92:95]
    s_waitcnt lgkmcnt(0)
    s_barrier
    v_mov_b32_e64 v18, s11
    v_mfma_f32_16x16x32_bf16 v[96:99], v[160:163], v[208:211], v[96:99]
    ds_read_b128 v[128:131], v20 offset:0
    v_mfma_f32_16x16x32_bf16 v[96:99], v[164:167], v[212:215], v[96:99]
    ds_read_b128 v[132:135], v20 offset:4096
    v_mfma_f32_16x16x32_bf16 v[100:103], v[160:163], v[216:219], v[100:103]
    ds_read_b128 v[136:139], v20 offset:8192
    v_cvt_pk_bf16_f32 v32, v64, v65
    v_cvt_pk_bf16_f32 v34, v72, v73
    v_mfma_f32_16x16x32_bf16 v[100:103], v[164:167], v[220:223], v[100:103]
    ds_read_b128 v[140:143], v20 offset:12288
    v_cvt_pk_bf16_f32 v33, v66, v67
    v_cvt_pk_bf16_f32 v35, v74, v75
    v_mfma_f32_16x16x32_bf16 v[104:107], v[168:171], v[208:211], v[104:107]
    ds_read_b128 v[144:147], v21 offset:0
    v_cvt_pk_bf16_f32 v36, v68, v69
    v_cvt_pk_bf16_f32 v38, v76, v77
    v_mfma_f32_16x16x32_bf16 v[104:107], v[172:175], v[212:215], v[104:107]
    ds_read_b128 v[148:151], v21 offset:4096
    v_cvt_pk_bf16_f32 v37, v70, v71
    v_cvt_pk_bf16_f32 v39, v78, v79
    v_mfma_f32_16x16x32_bf16 v[108:111], v[168:171], v[216:219], v[108:111]
    ds_read_b128 v[152:155], v21 offset:8192
    v_permlane16_swap_b32 v32, v34
    v_permlane16_swap_b32 v33, v35
    v_mfma_f32_16x16x32_bf16 v[108:111], v[172:175], v[220:223], v[108:111]
    ds_read_b128 v[156:159], v21 offset:12288
    v_permlane16_swap_b32 v36, v38
    v_permlane16_swap_b32 v37, v39
    v_mfma_f32_16x16x32_bf16 v[112:115], v[176:179], v[208:211], v[112:115]
    ds_read_b128 v[192:195], v22 offset:0
    v_cvt_pk_bf16_f32 v40, v80, v81
    v_cvt_pk_bf16_f32 v42, v88, v89
    v_mfma_f32_16x16x32_bf16 v[112:115], v[180:183], v[212:215], v[112:115]
    ds_read_b128 v[196:199], v22 offset:4096
    v_cvt_pk_bf16_f32 v41, v82, v83
    v_cvt_pk_bf16_f32 v43, v90, v91
    v_mfma_f32_16x16x32_bf16 v[116:119], v[176:179], v[216:219], v[116:119]
    ds_read_b128 v[200:203], v22 offset:8192
    v_cvt_pk_bf16_f32 v44, v84, v85
    v_cvt_pk_bf16_f32 v46, v92, v93
    v_mfma_f32_16x16x32_bf16 v[116:119], v[180:183], v[220:223], v[116:119]
    ds_read_b128 v[204:207], v22 offset:12288
    v_cvt_pk_bf16_f32 v45, v86, v87
    v_cvt_pk_bf16_f32 v47, v94, v95
    v_mfma_f32_16x16x32_bf16 v[120:123], v[184:187], v[208:211], v[120:123]
    ds_read_b128 v[224:227], v23 offset:0
    v_permlane16_swap_b32 v40, v42
    v_mfma_f32_16x16x32_bf16 v[120:123], v[188:191], v[212:215], v[120:123]
    ds_read_b128 v[228:231], v23 offset:4096
    v_permlane16_swap_b32 v41, v43
    v_mfma_f32_16x16x32_bf16 v[124:127], v[184:187], v[216:219], v[124:127]
    ds_read_b128 v[232:235], v23 offset:8192
    v_permlane16_swap_b32 v44, v46
    v_mfma_f32_16x16x32_bf16 v[124:127], v[188:191], v[220:223], v[124:127]
    ds_read_b128 v[236:239], v23 offset:12288
    v_permlane16_swap_b32 v45, v47
    s_waitcnt lgkmcnt(12)
    v_mfma_f32_16x16x32_bf16 v[160:163], v[128:131], v[32:35], 0
    ds_read_b64_tr_b16 v[64:65], v24 offset:0
    ds_read_b64_tr_b16 v[66:67], v24 offset:4096
    v_cvt_pk_bf16_f32 v48, v96, v97
    v_cvt_pk_bf16_f32 v50, v104, v105
    v_mfma_f32_16x16x32_bf16 v[164:167], v[132:135], v[32:35], 0
    ds_read_b64_tr_b16 v[68:69], v24 offset:8192
    ds_read_b64_tr_b16 v[70:71], v24 offset:12288
    v_cvt_pk_bf16_f32 v49, v98, v99
    v_cvt_pk_bf16_f32 v51, v106, v107
    v_mfma_f32_16x16x32_bf16 v[168:171], v[136:139], v[32:35], 0
    ds_read_b64_tr_b16 v[72:73], v25 offset:0
    ds_read_b64_tr_b16 v[74:75], v25 offset:4096
    v_cvt_pk_bf16_f32 v52, v100, v101
    v_cvt_pk_bf16_f32 v54, v108, v109
    v_mfma_f32_16x16x32_bf16 v[172:175], v[140:143], v[32:35], 0
    ds_read_b64_tr_b16 v[76:77], v25 offset:8192
    ds_read_b64_tr_b16 v[78:79], v25 offset:12288
    v_cvt_pk_bf16_f32 v53, v102, v103
    v_cvt_pk_bf16_f32 v55, v110, v111
    s_waitcnt lgkmcnt(8)
    v_mfma_f32_16x16x32_bf16 v[160:163], v[144:147], v[40:43], v[160:163]
    ds_read_b64_tr_b16 v[80:81], v26 offset:0
    ds_read_b64_tr_b16 v[82:83], v26 offset:4096
    v_permlane16_swap_b32 v48, v50
    v_permlane16_swap_b32 v49, v51
    v_mfma_f32_16x16x32_bf16 v[164:167], v[148:151], v[40:43], v[164:167]
    ds_read_b64_tr_b16 v[84:85], v26 offset:8192
    ds_read_b64_tr_b16 v[86:87], v26 offset:12288
    v_permlane16_swap_b32 v52, v54
    v_permlane16_swap_b32 v53, v55
    v_mfma_f32_16x16x32_bf16 v[168:171], v[152:155], v[40:43], v[168:171]
    ds_read_b64_tr_b16 v[88:89], v27 offset:0
    ds_read_b64_tr_b16 v[90:91], v27 offset:4096
    v_cvt_pk_bf16_f32 v56, v112, v113
    v_cvt_pk_bf16_f32 v58, v120, v121
    v_mfma_f32_16x16x32_bf16 v[172:175], v[156:159], v[40:43], v[172:175]
    ds_read_b64_tr_b16 v[92:93], v27 offset:8192
    ds_read_b64_tr_b16 v[94:95], v27 offset:12288
    v_cvt_pk_bf16_f32 v57, v114, v115
    v_cvt_pk_bf16_f32 v59, v122, v123
    v_mfma_f32_16x16x32_bf16 v[160:163], v[192:195], v[48:51], v[160:163]
    ds_read_b64_tr_b16 v[96:97], v28 offset:0
    ds_read_b64_tr_b16 v[98:99], v28 offset:4096
    v_cvt_pk_bf16_f32 v60, v116, v117
    v_cvt_pk_bf16_f32 v62, v124, v125
    v_mfma_f32_16x16x32_bf16 v[164:167], v[196:199], v[48:51], v[164:167]
    ds_read_b64_tr_b16 v[100:101], v28 offset:8192
    ds_read_b64_tr_b16 v[102:103], v28 offset:12288
    v_cvt_pk_bf16_f32 v61, v118, v119
    v_cvt_pk_bf16_f32 v63, v126, v127
    v_mfma_f32_16x16x32_bf16 v[168:171], v[200:203], v[48:51], v[168:171]
    ds_read_b64_tr_b16 v[104:105], v29 offset:0
    ds_read_b64_tr_b16 v[106:107], v29 offset:4096
    v_permlane16_swap_b32 v56, v58
    v_permlane16_swap_b32 v57, v59
    v_mfma_f32_16x16x32_bf16 v[172:175], v[204:207], v[48:51], v[172:175]
    ds_read_b64_tr_b16 v[108:109], v29 offset:8192
    ds_read_b64_tr_b16 v[110:111], v29 offset:12288
    v_permlane16_swap_b32 v60, v62
    v_permlane16_swap_b32 v61, v63
    v_mfma_f32_16x16x32_bf16 v[160:163], v[224:227], v[56:59], v[160:163]
    ds_read_b64_tr_b16 v[112:113], v30 offset:0
    ds_read_b64_tr_b16 v[114:115], v30 offset:4096
    v_mfma_f32_16x16x32_bf16 v[164:167], v[228:231], v[56:59], v[164:167]
    ds_read_b64_tr_b16 v[116:117], v30 offset:8192
    ds_read_b64_tr_b16 v[118:119], v30 offset:12288
    v_mfma_f32_16x16x32_bf16 v[168:171], v[232:235], v[56:59], v[168:171]
    ds_read_b64_tr_b16 v[120:121], v31 offset:0
    ds_read_b64_tr_b16 v[122:123], v31 offset:4096
    v_mfma_f32_16x16x32_bf16 v[172:175], v[236:239], v[56:59], v[172:175]
    ds_read_b64_tr_b16 v[124:125], v31 offset:8192
    ds_read_b64_tr_b16 v[126:127], v31 offset:12288
    v_max3_f32 v14, v160, v161, v162
    v_max3_f32 v15, v163, v164, v165
    v_max3_f32 v14, v14, v166, v167
    v_max3_f32 v15, v15, v168, v169
    v_max3_f32 v14, v14, v170, v171
    s_nop 0
    v_max3_f32 v15, v15, v172, v173
    v_max3_f32 v14, v14, v174, v175
    v_max_f32 v14, v14, v15
    v_mul_f32 v14, s11, v14
    v_mov_b32 v12, v14
    v_mov_b32 v13, v14
    v_pk_fma_f32 v[160:161], v[160:161], v[18:19], v[14:15] op_sel_hi:[1,0,0] neg_lo:[0,0,1] neg_hi:[0,0,1]
    v_pk_fma_f32 v[162:163], v[162:163], v[18:19], v[14:15] op_sel_hi:[1,0,0] neg_lo:[0,0,1] neg_hi:[0,0,1]
    v_permlane16_swap_b32 v12, v13
    v_max_f32 v12, v12, v13
    v_mov_b32 v13, v12
    v_pk_fma_f32 v[164:165], v[164:165], v[18:19], v[14:15] op_sel_hi:[1,0,0] neg_lo:[0,0,1] neg_hi:[0,0,1]
    v_pk_fma_f32 v[166:167], v[166:167], v[18:19], v[14:15] op_sel_hi:[1,0,0] neg_lo:[0,0,1] neg_hi:[0,0,1]
    v_permlane32_swap_b32 v12, v13
    v_max_f32 v12, v12, v13
    v_sub_f32_e64 v12, v14, v12
    v_pk_fma_f32 v[168:169], v[168:169], v[18:19], v[14:15] op_sel_hi:[1,0,0] neg_lo:[0,0,1] neg_hi:[0,0,1]
    v_pk_fma_f32 v[170:171], v[170:171], v[18:19], v[14:15] op_sel_hi:[1,0,0] neg_lo:[0,0,1] neg_hi:[0,0,1]
    v_pk_fma_f32 v[172:173], v[172:173], v[18:19], v[14:15] op_sel_hi:[1,0,0] neg_lo:[0,0,1] neg_hi:[0,0,1]
    v_pk_fma_f32 v[174:175], v[174:175], v[18:19], v[14:15] op_sel_hi:[1,0,0] neg_lo:[0,0,1] neg_hi:[0,0,1]
    v_exp_f32 v12, v12
    v_exp_f32 v160, v160
    v_exp_f32 v161, v161
    v_exp_f32 v162, v162
    v_exp_f32 v163, v163
    v_exp_f32 v164, v164
    v_exp_f32 v165, v165
    v_exp_f32 v166, v166
    v_exp_f32 v167, v167
    v_exp_f32 v168, v168
    v_exp_f32 v169, v169
    v_exp_f32 v170, v170
    v_exp_f32 v171, v171
    v_exp_f32 v172, v172
    v_exp_f32 v173, v173
    v_exp_f32 v174, v174
    v_exp_f32_e64 v175, v175
    v_pk_add_f32 v[16:17], v[160:161], v[162:163]
    v_pk_add_f32 v[14:15], v[164:165], v[166:167]
    v_pk_add_f32 v[16:17], v[16:17], v[168:169]
    v_pk_add_f32 v[14:15], v[14:15], v[170:171]
    v_pk_add_f32 v[16:17], v[16:17], v[172:173]
    v_pk_add_f32 v[14:15], v[14:15], v[174:175]
    v_pk_add_f32 v[16:17], v[16:17], v[14:15]
    v_add_f32 v16, v16, v17
    v_mul_f32 v17, v12, v16
    v_mul_f32 v16, v12, v16
    s_nop 1
    v_permlane16_swap_b32 v16, v17
    v_add_f32 v15, v16, v17
    v_add_f32 v16, v16, v17
    s_nop 1
    v_permlane32_swap_b32 v16, v15
    v_add_f32 v16, v16, v15
    v_rcp_f32 v16, v16
    s_nop 0
    v_mul_f32_e64 v16, v12, v16
    v_pk_mul_f32 v[160:161], v[160:161], v[16:17] op_sel_hi:[1,0]
    v_pk_mul_f32 v[162:163], v[162:163], v[16:17] op_sel_hi:[1,0]
    v_pk_mul_f32 v[164:165], v[164:165], v[16:17] op_sel_hi:[1,0]
    v_pk_mul_f32 v[166:167], v[166:167], v[16:17] op_sel_hi:[1,0]
    v_pk_mul_f32 v[168:169], v[168:169], v[16:17] op_sel_hi:[1,0]
    v_pk_mul_f32 v[170:171], v[170:171], v[16:17] op_sel_hi:[1,0]
    v_pk_mul_f32 v[172:173], v[172:173], v[16:17] op_sel_hi:[1,0]
    v_pk_mul_f32 v[174:175], v[174:175], v[16:17] op_sel_hi:[1,0]
    v_cvt_pk_bf16_f32 v176, v160, v161
    v_cvt_pk_bf16_f32 v177, v162, v163
    v_cvt_pk_bf16_f32 v178, v164, v165
    v_cvt_pk_bf16_f32 v179, v166, v167
    v_cvt_pk_bf16_f32 v180, v168, v169
    v_cvt_pk_bf16_f32 v181, v170, v171
    v_cvt_pk_bf16_f32 v182, v172, v173
    v_cvt_pk_bf16_f32 v183, v174, v175
    s_mov_b32 s12, s10
    s_waitcnt lgkmcnt(0)
    s_barrier
    v_mfma_f32_16x16x32_bf16 v[208:211], v[64:67], v[176:179], 0
    ds_read_b128 v[128:131], v20 offset:32768
    ds_read_b128 v[132:135], v20 offset:36864
    v_mfma_f32_16x16x32_bf16 v[208:211], v[68:71], v[180:183], v[208:211]
    ds_read_b128 v[136:139], v20 offset:40960
    v_mfma_f32_16x16x32_bf16 v[212:215], v[72:75], v[176:179], 0
    ds_read_b128 v[140:143], v20 offset:45056
    v_mfma_f32_16x16x32_bf16 v[212:215], v[76:79], v[180:183], v[212:215]
    ds_read_b128 v[144:147], v21 offset:32768
    v_mfma_f32_16x16x32_bf16 v[216:219], v[80:83], v[176:179], 0
    ds_read_b128 v[148:151], v21 offset:36864
    ds_read_b128 v[152:155], v21 offset:40960
    v_mfma_f32_16x16x32_bf16 v[216:219], v[84:87], v[180:183], v[216:219]
    ds_read_b128 v[156:159], v21 offset:45056
    v_cvt_pk_bf16_f32 v240, v208, v209
    v_cvt_pk_bf16_f32 v241, v210, v211
    v_mfma_f32_16x16x32_bf16 v[220:223], v[88:91], v[176:179], 0
    ds_read_b128 v[192:195], v22 offset:32768
    v_cvt_pk_bf16_f32 v242, v212, v213
    v_mfma_f32_16x16x32_bf16 v[220:223], v[92:95], v[180:183], v[220:223]
    ds_read_b128 v[196:199], v22 offset:36864
    v_cvt_pk_bf16_f32 v243, v214, v215
    v_mfma_f32_16x16x32_bf16 v[32:35], v[96:99], v[176:179], 0
    buffer_store_dwordx4 v[240:243], v2, s[56:59], s12 offen offset:0 sc1
    v_mfma_f32_16x16x32_bf16 v[32:35], v[100:103], v[180:183], v[32:35]
    ds_read_b128 v[200:203], v22 offset:40960
    v_cvt_pk_bf16_f32 v244, v216, v217
    v_cvt_pk_bf16_f32 v245, v218, v219
    v_mfma_f32_16x16x32_bf16 v[40:43], v[104:107], v[176:179], 0
    ds_read_b128 v[204:207], v22 offset:45056
    v_cvt_pk_bf16_f32 v246, v220, v221
    v_mfma_f32_16x16x32_bf16 v[40:43], v[108:111], v[180:183], v[40:43]
    ds_read_b128 v[224:227], v23 offset:32768
    v_cvt_pk_bf16_f32 v247, v222, v223
    v_mfma_f32_16x16x32_bf16 v[48:51], v[112:115], v[176:179], 0
    buffer_store_dwordx4 v[244:247], v2, s[56:59], s12 offen offset:1024 sc1
    v_mfma_f32_16x16x32_bf16 v[48:51], v[116:119], v[180:183], v[48:51]
    ds_read_b128 v[228:231], v23 offset:36864
    v_cvt_pk_bf16_f32 v248, v32, v33
    v_cvt_pk_bf16_f32 v249, v34, v35
    v_mfma_f32_16x16x32_bf16 v[56:59], v[120:123], v[176:179], 0
    ds_read_b128 v[232:235], v23 offset:40960
    v_cvt_pk_bf16_f32 v250, v40, v41
    v_mfma_f32_16x16x32_bf16 v[56:59], v[124:127], v[180:183], v[56:59]
    ds_read_b128 v[236:239], v23 offset:45056
    v_cvt_pk_bf16_f32 v251, v42, v43
    s_waitcnt lgkmcnt(8)
    v_mfma_f32_16x16x32_bf16 v[160:163], v[128:131], v[36:39], 0
    buffer_store_dwordx4 v[248:251], v2, s[56:59], s12 offen offset:2048 sc1
    v_mfma_f32_16x16x32_bf16 v[164:167], v[132:135], v[36:39], 0
    ds_read_b64_tr_b16 v[64:65], v24 offset:32768
    ds_read_b64_tr_b16 v[66:67], v24 offset:36864
    v_cvt_pk_bf16_f32 v252, v48, v49
    v_cvt_pk_bf16_f32 v253, v50, v51
    v_mfma_f32_16x16x32_bf16 v[168:171], v[136:139], v[36:39], 0
    ds_read_b64_tr_b16 v[68:69], v24 offset:40960
    ds_read_b64_tr_b16 v[70:71], v24 offset:45056
    v_cvt_pk_bf16_f32 v254, v56, v57
    v_mfma_f32_16x16x32_bf16 v[172:175], v[140:143], v[36:39], 0
    ds_read_b64_tr_b16 v[72:73], v25 offset:32768
    ds_read_b64_tr_b16 v[74:75], v25 offset:36864
    v_cvt_pk_bf16_f32 v255, v58, v59
    v_mfma_f32_16x16x32_bf16 v[160:163], v[144:147], v[44:47], v[160:163]
    buffer_store_dwordx4 v[252:255], v2, s[56:59], s12 offen offset:3072 sc1
    v_mfma_f32_16x16x32_bf16 v[164:167], v[148:151], v[44:47], v[164:167]
    ds_read_b64_tr_b16 v[76:77], v25 offset:40960
    ds_read_b64_tr_b16 v[78:79], v25 offset:45056
    ds_read_b64_tr_b16 v[80:81], v26 offset:32768
    v_mfma_f32_16x16x32_bf16 v[168:171], v[152:155], v[44:47], v[168:171]
    ds_read_b64_tr_b16 v[82:83], v26 offset:36864
    ds_read_b64_tr_b16 v[84:85], v26 offset:40960
    v_mfma_f32_16x16x32_bf16 v[172:175], v[156:159], v[44:47], v[172:175]
    ds_read_b64_tr_b16 v[86:87], v26 offset:45056
    ds_read_b64_tr_b16 v[88:89], v27 offset:32768
    s_waitcnt lgkmcnt(13)
    v_mfma_f32_16x16x32_bf16 v[160:163], v[192:195], v[52:55], v[160:163]
    ds_read_b64_tr_b16 v[90:91], v27 offset:36864
    ds_read_b64_tr_b16 v[92:93], v27 offset:40960
    ds_read_b64_tr_b16 v[94:95], v27 offset:45056
    v_mfma_f32_16x16x32_bf16 v[164:167], v[196:199], v[52:55], v[164:167]
    ds_read_b64_tr_b16 v[96:97], v28 offset:32768
    ds_read_b64_tr_b16 v[98:99], v28 offset:36864
    v_mfma_f32_16x16x32_bf16 v[168:171], v[200:203], v[52:55], v[168:171]
    ds_read_b64_tr_b16 v[100:101], v28 offset:40960
    ds_read_b64_tr_b16 v[102:103], v28 offset:45056
    v_mfma_f32_16x16x32_bf16 v[172:175], v[204:207], v[52:55], v[172:175]
    ds_read_b64_tr_b16 v[104:105], v29 offset:32768
    ds_read_b64_tr_b16 v[106:107], v29 offset:36864
    ds_read_b64_tr_b16 v[108:109], v29 offset:40960
    v_mfma_f32_16x16x32_bf16 v[160:163], v[224:227], v[60:63], v[160:163]
    ds_read_b64_tr_b16 v[110:111], v29 offset:45056
    ds_read_b64_tr_b16 v[112:113], v30 offset:32768
    v_mfma_f32_16x16x32_bf16 v[164:167], v[228:231], v[60:63], v[164:167]
    ds_read_b64_tr_b16 v[114:115], v30 offset:36864
    ds_read_b64_tr_b16 v[116:117], v30 offset:40960
    v_mfma_f32_16x16x32_bf16 v[168:171], v[232:235], v[60:63], v[168:171]
    ds_read_b64_tr_b16 v[118:119], v30 offset:45056
    ds_read_b64_tr_b16 v[120:121], v31 offset:32768
    ds_read_b64_tr_b16 v[122:123], v31 offset:36864
    v_mfma_f32_16x16x32_bf16 v[172:175], v[236:239], v[60:63], v[172:175]
    ds_read_b64_tr_b16 v[124:125], v31 offset:40960
    ds_read_b64_tr_b16 v[126:127], v31 offset:45056
    ds_write_b128 v3, v[240:243] offset:0
    ds_write_b128 v3, v[244:247] offset:1024
    v_max3_f32 v14, v160, v161, v162
    v_max3_f32 v15, v163, v164, v165
    v_max3_f32 v14, v14, v166, v167
    v_max3_f32 v15, v15, v168, v169
    v_max3_f32 v14, v14, v170, v171
    v_max3_f32 v15, v15, v172, v173
    v_max3_f32 v14, v14, v174, v175
    v_max_f32 v14, v14, v15
    v_mul_f32 v14, s11, v14
    v_mov_b32 v12, v14
    v_mov_b32 v13, v14
    v_pk_fma_f32 v[160:161], v[160:161], v[18:19], v[14:15] op_sel_hi:[1,0,0] neg_lo:[0,0,1] neg_hi:[0,0,1]
    v_pk_fma_f32 v[162:163], v[162:163], v[18:19], v[14:15] op_sel_hi:[1,0,0] neg_lo:[0,0,1] neg_hi:[0,0,1]
    v_permlane16_swap_b32 v12, v13
    v_max_f32 v12, v12, v13
    v_mov_b32 v13, v12
    v_pk_fma_f32 v[164:165], v[164:165], v[18:19], v[14:15] op_sel_hi:[1,0,0] neg_lo:[0,0,1] neg_hi:[0,0,1]
    v_pk_fma_f32 v[166:167], v[166:167], v[18:19], v[14:15] op_sel_hi:[1,0,0] neg_lo:[0,0,1] neg_hi:[0,0,1]
    v_permlane32_swap_b32 v12, v13
    v_max_f32 v12, v12, v13
    v_sub_f32_e64 v12, v14, v12
    v_pk_fma_f32 v[168:169], v[168:169], v[18:19], v[14:15] op_sel_hi:[1,0,0] neg_lo:[0,0,1] neg_hi:[0,0,1]
    v_pk_fma_f32 v[170:171], v[170:171], v[18:19], v[14:15] op_sel_hi:[1,0,0] neg_lo:[0,0,1] neg_hi:[0,0,1]
    v_pk_fma_f32 v[172:173], v[172:173], v[18:19], v[14:15] op_sel_hi:[1,0,0] neg_lo:[0,0,1] neg_hi:[0,0,1]
    v_pk_fma_f32 v[174:175], v[174:175], v[18:19], v[14:15] op_sel_hi:[1,0,0] neg_lo:[0,0,1] neg_hi:[0,0,1]
    v_exp_f32 v12, v12
    v_exp_f32 v160, v160
    v_exp_f32 v161, v161
    v_exp_f32 v162, v162
    v_exp_f32 v163, v163
    ds_write_b128 v3, v[248:251] offset:2048
    ds_write_b128 v3, v[252:255] offset:3072
    v_exp_f32 v164, v164
    v_exp_f32 v165, v165
    v_exp_f32 v166, v166
    v_exp_f32 v167, v167
    v_exp_f32 v168, v168
    v_exp_f32 v169, v169
    v_exp_f32 v170, v170
    v_exp_f32 v171, v171
    v_exp_f32 v172, v172
    v_exp_f32 v173, v173
    v_exp_f32 v174, v174
    v_exp_f32_e64 v175, v175
    v_pk_add_f32 v[16:17], v[160:161], v[162:163]
    v_pk_add_f32 v[14:15], v[164:165], v[166:167]
    v_pk_add_f32 v[16:17], v[16:17], v[168:169]
    v_pk_add_f32 v[14:15], v[14:15], v[170:171]
    v_pk_add_f32 v[16:17], v[16:17], v[172:173]
    v_pk_add_f32 v[14:15], v[14:15], v[174:175]
    v_pk_add_f32 v[16:17], v[16:17], v[14:15]
    v_add_f32 v16, v16, v17
    v_mul_f32 v17, v12, v16
    v_mul_f32 v16, v12, v16
    s_nop 1
    v_permlane16_swap_b32 v16, v17
    v_add_f32 v15, v16, v17
    v_add_f32 v16, v16, v17
    s_nop 1
    v_permlane32_swap_b32 v16, v15
    v_add_f32 v16, v16, v15
    v_rcp_f32 v16, v16
    s_nop 0
    v_mul_f32_e64 v16, v12, v16
    v_pk_mul_f32 v[160:161], v[160:161], v[16:17] op_sel_hi:[1,0]
    v_pk_mul_f32 v[162:163], v[162:163], v[16:17] op_sel_hi:[1,0]
    v_pk_mul_f32 v[164:165], v[164:165], v[16:17] op_sel_hi:[1,0]
    v_pk_mul_f32 v[166:167], v[166:167], v[16:17] op_sel_hi:[1,0]
    v_pk_mul_f32 v[168:169], v[168:169], v[16:17] op_sel_hi:[1,0]
    v_pk_mul_f32 v[170:171], v[170:171], v[16:17] op_sel_hi:[1,0]
    v_pk_mul_f32 v[172:173], v[172:173], v[16:17] op_sel_hi:[1,0]
    v_pk_mul_f32 v[174:175], v[174:175], v[16:17] op_sel_hi:[1,0]
    v_cvt_pk_bf16_f32 v192, v160, v161
    v_cvt_pk_bf16_f32 v193, v162, v163
    v_cvt_pk_bf16_f32 v194, v164, v165
    v_cvt_pk_bf16_f32 v195, v166, v167
    v_cvt_pk_bf16_f32 v196, v168, v169
    v_cvt_pk_bf16_f32 v197, v170, v171
    v_cvt_pk_bf16_f32 v198, v172, v173
    v_cvt_pk_bf16_f32 v199, v174, v175
    s_add_u32 s12, s10, 524288
    v_lshlrev_b32 v63, 9, v2
    v_mov_b32 v62, 1
    s_waitcnt lgkmcnt(0)
    v_mfma_f32_16x16x32_bf16 v[208:211], v[64:67], v[192:195], 0
    v_mfma_f32_16x16x32_bf16 v[208:211], v[68:71], v[196:199], v[208:211]
    v_mfma_f32_16x16x32_bf16 v[212:215], v[72:75], v[192:195], 0
    v_mfma_f32_16x16x32_bf16 v[212:215], v[76:79], v[196:199], v[212:215]
    v_mfma_f32_16x16x32_bf16 v[216:219], v[80:83], v[192:195], 0
    v_mfma_f32_16x16x32_bf16 v[216:219], v[84:87], v[196:199], v[216:219]
    s_nop 3
    v_cvt_pk_bf16_f32 v240, v208, v209
    v_cvt_pk_bf16_f32 v241, v210, v211
    v_mfma_f32_16x16x32_bf16 v[220:223], v[88:91], v[192:195], 0
    v_cvt_pk_bf16_f32 v242, v212, v213
    v_mfma_f32_16x16x32_bf16 v[220:223], v[92:95], v[196:199], v[220:223]
    s_mov_b64 exec, 15
    s_waitcnt vmcnt(0)
    buffer_store_dword v62, v63, s[56:59], s13 offen sc1
    s_mov_b64 exec, -1
    v_cvt_pk_bf16_f32 v243, v214, v215
    v_mfma_f32_16x16x32_bf16 v[32:35], v[96:99], v[192:195], 0
    buffer_store_dwordx4 v[240:243], v2, s[56:59], s12 offen offset:0 sc1
    v_mfma_f32_16x16x32_bf16 v[32:35], v[100:103], v[196:199], v[32:35]
    ds_write_b128 v3, v[240:243] offset:16384
    v_cvt_pk_bf16_f32 v244, v216, v217
    v_cvt_pk_bf16_f32 v245, v218, v219
    v_mfma_f32_16x16x32_bf16 v[40:43], v[104:107], v[192:195], 0
    v_cvt_pk_bf16_f32 v246, v220, v221
    v_mfma_f32_16x16x32_bf16 v[40:43], v[108:111], v[196:199], v[40:43]
    v_cvt_pk_bf16_f32 v247, v222, v223
    v_mfma_f32_16x16x32_bf16 v[48:51], v[112:115], v[192:195], 0
    buffer_store_dwordx4 v[244:247], v2, s[56:59], s12 offen offset:1024 sc1
    v_mfma_f32_16x16x32_bf16 v[48:51], v[116:119], v[196:199], v[48:51]
    ds_write_b128 v3, v[244:247] offset:17408
    v_cvt_pk_bf16_f32 v248, v32, v33
    v_cvt_pk_bf16_f32 v249, v34, v35
    v_mfma_f32_16x16x32_bf16 v[56:59], v[120:123], v[192:195], 0
    v_cvt_pk_bf16_f32 v250, v40, v41
    v_mfma_f32_16x16x32_bf16 v[56:59], v[124:127], v[196:199], v[56:59]
    v_cvt_pk_bf16_f32 v251, v42, v43
    buffer_store_dwordx4 v[248:251], v2, s[56:59], s12 offen offset:2048 sc1
    ds_write_b128 v3, v[248:251] offset:18432
    v_cvt_pk_bf16_f32 v252, v48, v49
    v_cvt_pk_bf16_f32 v253, v50, v51
    s_nop 2
    v_cvt_pk_bf16_f32 v254, v56, v57
    v_cvt_pk_bf16_f32 v255, v58, v59
    buffer_store_dwordx4 v[252:255], v2, s[56:59], s12 offen offset:3072 sc1
    ds_write_b128 v3, v[252:255] offset:19456
    s_waitcnt lgkmcnt(0)
    s_barrier
    ds_read_b64_tr_b16 v[128:129], v4 offset:0
    ds_read_b64_tr_b16 v[130:131], v4 offset:4096
    ds_read_b64_tr_b16 v[132:133], v5 offset:0
    ds_read_b64_tr_b16 v[134:135], v5 offset:4096
    ds_read_b64_tr_b16 v[136:137], v4 offset:8192
    ds_read_b64_tr_b16 v[138:139], v4 offset:12288
    ds_read_b64_tr_b16 v[140:141], v5 offset:8192
    ds_read_b64_tr_b16 v[142:143], v5 offset:12288
    ds_read_b64_tr_b16 v[144:145], v4 offset:16384
    ds_read_b64_tr_b16 v[146:147], v4 offset:20480
    ds_read_b64_tr_b16 v[148:149], v5 offset:16384
    ds_read_b64_tr_b16 v[150:151], v5 offset:20480
    ds_read_b64_tr_b16 v[152:153], v4 offset:24576
    ds_read_b64_tr_b16 v[154:155], v4 offset:28672
    ds_read_b64_tr_b16 v[156:157], v5 offset:24576
    ds_read_b64_tr_b16 v[158:159], v5 offset:28672
    s_branch L_pg4
.p2align 12
L_pad4:
    s_branch L_compute
    s_nop 0
L_pg4:
    ds_read_b128 v[10:13], v9 offset:0
    ds_read_b128 v[14:17], v9 offset:1024
    ds_read_b128 v[18:21], v9 offset:2048
    ds_read_b128 v[22:25], v9 offset:3072
    s_waitcnt lgkmcnt(2)
    v_mfma_f32_16x16x32_bf16 v[192:195], v[128:131], v[10:13], 0
    ds_read_b128 v[26:29], v9 offset:4096
    v_mfma_f32_16x16x32_bf16 v[192:195], v[136:139], v[14:17], v[192:195]
    ds_read_b128 v[30:33], v9 offset:5120
    s_waitcnt lgkmcnt(2)
    v_mfma_f32_16x16x32_bf16 v[192:195], v[144:147], v[18:21], v[192:195]
    ds_read_b128 v[34:37], v9 offset:6144
    v_mfma_f32_16x16x32_bf16 v[192:195], v[152:155], v[22:25], v[192:195]
    ds_read_b128 v[38:41], v9 offset:7168
    v_mfma_f32_16x16x32_bf16 v[196:199], v[132:135], v[10:13], 0
    ds_read_b64_tr_b16 v[160:161], v4 offset:32768
    v_mfma_f32_16x16x32_bf16 v[196:199], v[140:143], v[14:17], v[196:199]
    ds_read_b64_tr_b16 v[162:163], v4 offset:36864
    v_mfma_f32_16x16x32_bf16 v[196:199], v[148:151], v[18:21], v[196:199]
    ds_read_b64_tr_b16 v[164:165], v5 offset:32768
    v_mfma_f32_16x16x32_bf16 v[196:199], v[156:159], v[22:25], v[196:199]
    ds_read_b64_tr_b16 v[166:167], v5 offset:36864
    s_waitcnt lgkmcnt(6)
    v_mfma_f32_16x16x32_bf16 v[200:203], v[128:131], v[26:29], 0
    ds_read_b128 v[10:13], v9 offset:8192
    v_mfma_f32_16x16x32_bf16 v[200:203], v[136:139], v[30:33], v[200:203]
    ds_read_b128 v[14:17], v9 offset:9216
    s_waitcnt lgkmcnt(6)
    v_mfma_f32_16x16x32_bf16 v[200:203], v[144:147], v[34:37], v[200:203]
    ds_read_b128 v[18:21], v9 offset:10240
    v_mfma_f32_16x16x32_bf16 v[200:203], v[152:155], v[38:41], v[200:203]
    ds_read_b128 v[22:25], v9 offset:11264
    v_mfma_f32_16x16x32_bf16 v[204:207], v[132:135], v[26:29], 0
    ds_read_b64_tr_b16 v[168:169], v4 offset:40960
    v_mfma_f32_16x16x32_bf16 v[204:207], v[140:143], v[30:33], v[204:207]
    ds_read_b64_tr_b16 v[170:171], v4 offset:45056
    v_mfma_f32_16x16x32_bf16 v[204:207], v[148:151], v[34:37], v[204:207]
    ds_read_b64_tr_b16 v[172:173], v5 offset:40960
    v_mfma_f32_16x16x32_bf16 v[204:207], v[156:159], v[38:41], v[204:207]
    ds_read_b64_tr_b16 v[174:175], v5 offset:45056
    s_waitcnt lgkmcnt(6)
    v_mfma_f32_16x16x32_bf16 v[208:211], v[128:131], v[10:13], 0
    ds_read_b128 v[26:29], v9 offset:12288
    v_mfma_f32_16x16x32_bf16 v[208:211], v[136:139], v[14:17], v[208:211]
    ds_read_b128 v[30:33], v9 offset:13312
    s_waitcnt lgkmcnt(6)
    v_mfma_f32_16x16x32_bf16 v[208:211], v[144:147], v[18:21], v[208:211]
    ds_read_b128 v[34:37], v9 offset:14336
    v_mfma_f32_16x16x32_bf16 v[208:211], v[152:155], v[22:25], v[208:211]
    ds_read_b128 v[38:41], v9 offset:15360
    v_mfma_f32_16x16x32_bf16 v[212:215], v[132:135], v[10:13], 0
    ds_read_b64_tr_b16 v[176:177], v4 offset:49152
    v_mfma_f32_16x16x32_bf16 v[212:215], v[140:143], v[14:17], v[212:215]
    ds_read_b64_tr_b16 v[178:179], v4 offset:53248
    v_mfma_f32_16x16x32_bf16 v[212:215], v[148:151], v[18:21], v[212:215]
    ds_read_b64_tr_b16 v[180:181], v5 offset:49152
    v_mfma_f32_16x16x32_bf16 v[212:215], v[156:159], v[22:25], v[212:215]
    ds_read_b64_tr_b16 v[182:183], v5 offset:53248
    s_waitcnt lgkmcnt(6)
    v_mfma_f32_16x16x32_bf16 v[216:219], v[128:131], v[26:29], 0
    ds_read_b128 v[10:13], v9 offset:16384
    v_mfma_f32_16x16x32_bf16 v[216:219], v[136:139], v[30:33], v[216:219]
    ds_read_b128 v[14:17], v9 offset:17408
    s_waitcnt lgkmcnt(6)
    v_mfma_f32_16x16x32_bf16 v[216:219], v[144:147], v[34:37], v[216:219]
    ds_read_b128 v[18:21], v9 offset:18432
    v_mfma_f32_16x16x32_bf16 v[216:219], v[152:155], v[38:41], v[216:219]
    ds_read_b128 v[22:25], v9 offset:19456
    v_mfma_f32_16x16x32_bf16 v[220:223], v[132:135], v[26:29], 0
    ds_read_b64_tr_b16 v[184:185], v4 offset:57344
    v_mfma_f32_16x16x32_bf16 v[220:223], v[140:143], v[30:33], v[220:223]
    ds_read_b64_tr_b16 v[186:187], v4 offset:61440
    v_mfma_f32_16x16x32_bf16 v[220:223], v[148:151], v[34:37], v[220:223]
    ds_read_b64_tr_b16 v[188:189], v5 offset:57344
    v_mfma_f32_16x16x32_bf16 v[220:223], v[156:159], v[38:41], v[220:223]
    ds_read_b64_tr_b16 v[190:191], v5 offset:61440
    s_waitcnt lgkmcnt(0)
    s_barrier
    s_waitcnt lgkmcnt(2)
    v_mfma_f32_16x16x32_bf16 v[224:227], v[128:131], v[10:13], 0
    ds_read_b128 v[26:29], v9 offset:20480
    v_mfma_f32_16x16x32_bf16 v[224:227], v[136:139], v[14:17], v[224:227]
    ds_read_b128 v[30:33], v9 offset:21504
    s_waitcnt lgkmcnt(2)
    v_mfma_f32_16x16x32_bf16 v[224:227], v[144:147], v[18:21], v[224:227]
    ds_read_b128 v[34:37], v9 offset:22528
    v_mfma_f32_16x16x32_bf16 v[224:227], v[152:155], v[22:25], v[224:227]
    ds_read_b128 v[38:41], v9 offset:23552
    v_mfma_f32_16x16x32_bf16 v[228:231], v[132:135], v[10:13], 0
    v_mfma_f32_16x16x32_bf16 v[228:231], v[140:143], v[14:17], v[228:231]
    v_mfma_f32_16x16x32_bf16 v[228:231], v[148:151], v[18:21], v[228:231]
    v_mfma_f32_16x16x32_bf16 v[228:231], v[156:159], v[22:25], v[228:231]
    s_waitcnt lgkmcnt(2)
    v_mfma_f32_16x16x32_bf16 v[232:235], v[128:131], v[26:29], 0
    ds_read_b128 v[10:13], v9 offset:24576
    v_mfma_f32_16x16x32_bf16 v[232:235], v[136:139], v[30:33], v[232:235]
    ds_read_b128 v[14:17], v9 offset:25600
    s_waitcnt lgkmcnt(2)
    v_mfma_f32_16x16x32_bf16 v[232:235], v[144:147], v[34:37], v[232:235]
    ds_read_b128 v[18:21], v9 offset:26624
    v_mfma_f32_16x16x32_bf16 v[232:235], v[152:155], v[38:41], v[232:235]
    ds_read_b128 v[22:25], v9 offset:27648
    v_mfma_f32_16x16x32_bf16 v[236:239], v[132:135], v[26:29], 0
    v_mfma_f32_16x16x32_bf16 v[236:239], v[140:143], v[30:33], v[236:239]
    v_mfma_f32_16x16x32_bf16 v[236:239], v[148:151], v[34:37], v[236:239]
    v_mfma_f32_16x16x32_bf16 v[236:239], v[156:159], v[38:41], v[236:239]
    v_lshlrev_b32 v63, 9, v2
    v_mov_b32 v62, 2
    s_mov_b64 exec, 15
    s_waitcnt vmcnt(0)
    buffer_store_dword v62, v63, s[56:59], s13 offen sc1
    s_mov_b64 exec, -1
    s_waitcnt lgkmcnt(2)
    v_mfma_f32_16x16x32_bf16 v[240:243], v[128:131], v[10:13], 0
    v_mfma_f32_16x16x32_bf16 v[240:243], v[136:139], v[14:17], v[240:243]
    s_waitcnt lgkmcnt(0)
    v_mfma_f32_16x16x32_bf16 v[240:243], v[144:147], v[18:21], v[240:243]
    v_mfma_f32_16x16x32_bf16 v[240:243], v[152:155], v[22:25], v[240:243]
    v_mfma_f32_16x16x32_bf16 v[244:247], v[132:135], v[10:13], 0
    v_mfma_f32_16x16x32_bf16 v[244:247], v[140:143], v[14:17], v[244:247]
    v_mfma_f32_16x16x32_bf16 v[244:247], v[148:151], v[18:21], v[244:247]
    v_mfma_f32_16x16x32_bf16 v[244:247], v[156:159], v[22:25], v[244:247]
    s_barrier
    ds_read_b128 v[26:29], v8 offset:0
    ds_read_b128 v[30:33], v8 offset:1024
    ds_read_b128 v[34:37], v8 offset:2048
    ds_read_b128 v[38:41], v8 offset:3072
    ds_read_b64_tr_b16 v[64:65], v6 offset:0
    ds_read_b64_tr_b16 v[66:67], v6 offset:4096
    ds_read_b64_tr_b16 v[68:69], v7 offset:0
    ds_read_b64_tr_b16 v[70:71], v7 offset:4096
    s_waitcnt lgkmcnt(6)
    v_mfma_f32_16x16x32_bf16 v[192:195], v[160:163], v[26:29], v[192:195]
    ds_read_b128 v[10:13], v8 offset:4096
    v_mfma_f32_16x16x32_bf16 v[192:195], v[168:171], v[30:33], v[192:195]
    ds_read_b128 v[14:17], v8 offset:5120
    s_waitcnt lgkmcnt(6)
    v_mfma_f32_16x16x32_bf16 v[192:195], v[176:179], v[34:37], v[192:195]
    ds_read_b128 v[18:21], v8 offset:6144
    v_mfma_f32_16x16x32_bf16 v[192:195], v[184:187], v[38:41], v[192:195]
    ds_read_b128 v[22:25], v8 offset:7168
    v_mfma_f32_16x16x32_bf16 v[196:199], v[164:167], v[26:29], v[196:199]
    ds_read_b64_tr_b16 v[72:73], v6 offset:8192
    v_mfma_f32_16x16x32_bf16 v[196:199], v[172:175], v[30:33], v[196:199]
    ds_read_b64_tr_b16 v[74:75], v6 offset:12288
    v_mfma_f32_16x16x32_bf16 v[196:199], v[180:183], v[34:37], v[196:199]
    ds_read_b64_tr_b16 v[76:77], v7 offset:8192
    v_mfma_f32_16x16x32_bf16 v[196:199], v[188:191], v[38:41], v[196:199]
    ds_read_b64_tr_b16 v[78:79], v7 offset:12288
    s_waitcnt lgkmcnt(6)
    v_mfma_f32_16x16x32_bf16 v[200:203], v[160:163], v[10:13], v[200:203]
    ds_read_b128 v[26:29], v8 offset:8192
    v_mfma_f32_16x16x32_bf16 v[200:203], v[168:171], v[14:17], v[200:203]
    ds_read_b128 v[30:33], v8 offset:9216
    s_waitcnt lgkmcnt(6)
    v_mfma_f32_16x16x32_bf16 v[200:203], v[176:179], v[18:21], v[200:203]
    ds_read_b128 v[34:37], v8 offset:10240
    v_mfma_f32_16x16x32_bf16 v[200:203], v[184:187], v[22:25], v[200:203]
    ds_read_b128 v[38:41], v8 offset:11264
    v_mfma_f32_16x16x32_bf16 v[204:207], v[164:167], v[10:13], v[204:207]
    ds_read_b64_tr_b16 v[80:81], v6 offset:16384
    v_mfma_f32_16x16x32_bf16 v[204:207], v[172:175], v[14:17], v[204:207]
    ds_read_b64_tr_b16 v[82:83], v6 offset:20480
    v_mfma_f32_16x16x32_bf16 v[204:207], v[180:183], v[18:21], v[204:207]
    ds_read_b64_tr_b16 v[84:85], v7 offset:16384
    v_mfma_f32_16x16x32_bf16 v[204:207], v[188:191], v[22:25], v[204:207]
    ds_read_b64_tr_b16 v[86:87], v7 offset:20480
    s_waitcnt lgkmcnt(6)
    v_mfma_f32_16x16x32_bf16 v[208:211], v[160:163], v[26:29], v[208:211]
    ds_read_b128 v[10:13], v8 offset:12288
    v_mfma_f32_16x16x32_bf16 v[208:211], v[168:171], v[30:33], v[208:211]
    ds_read_b128 v[14:17], v8 offset:13312
    s_waitcnt lgkmcnt(6)
    v_mfma_f32_16x16x32_bf16 v[208:211], v[176:179], v[34:37], v[208:211]
    ds_read_b128 v[18:21], v8 offset:14336
    v_mfma_f32_16x16x32_bf16 v[208:211], v[184:187], v[38:41], v[208:211]
    ds_read_b128 v[22:25], v8 offset:15360
    v_mfma_f32_16x16x32_bf16 v[212:215], v[164:167], v[26:29], v[212:215]
    ds_read_b64_tr_b16 v[88:89], v6 offset:24576
    v_mfma_f32_16x16x32_bf16 v[212:215], v[172:175], v[30:33], v[212:215]
    ds_read_b64_tr_b16 v[90:91], v6 offset:28672
    v_mfma_f32_16x16x32_bf16 v[212:215], v[180:183], v[34:37], v[212:215]
    ds_read_b64_tr_b16 v[92:93], v7 offset:24576
    v_mfma_f32_16x16x32_bf16 v[212:215], v[188:191], v[38:41], v[212:215]
    ds_read_b64_tr_b16 v[94:95], v7 offset:28672
    s_waitcnt lgkmcnt(0)
    s_barrier
    s_waitcnt lgkmcnt(2)
    v_mfma_f32_16x16x32_bf16 v[216:219], v[160:163], v[10:13], v[216:219]
    ds_read_b128 v[26:29], v8 offset:16384
    v_mfma_f32_16x16x32_bf16 v[216:219], v[168:171], v[14:17], v[216:219]
    ds_read_b128 v[30:33], v8 offset:17408
    s_waitcnt lgkmcnt(2)
    v_mfma_f32_16x16x32_bf16 v[216:219], v[176:179], v[18:21], v[216:219]
    ds_read_b128 v[34:37], v8 offset:18432
    v_mfma_f32_16x16x32_bf16 v[216:219], v[184:187], v[22:25], v[216:219]
    ds_read_b128 v[38:41], v8 offset:19456
    v_mfma_f32_16x16x32_bf16 v[220:223], v[164:167], v[10:13], v[220:223]
    ds_read_b64_tr_b16 v[96:97], v6 offset:32768
    v_mfma_f32_16x16x32_bf16 v[220:223], v[172:175], v[14:17], v[220:223]
    ds_read_b64_tr_b16 v[98:99], v6 offset:36864
    v_mfma_f32_16x16x32_bf16 v[220:223], v[180:183], v[18:21], v[220:223]
    ds_read_b64_tr_b16 v[100:101], v7 offset:32768
    v_mfma_f32_16x16x32_bf16 v[220:223], v[188:191], v[22:25], v[220:223]
    ds_read_b64_tr_b16 v[102:103], v7 offset:36864
    s_waitcnt lgkmcnt(6)
    v_mfma_f32_16x16x32_bf16 v[192:195], v[64:67], v[26:29], v[192:195]
    ds_read_b128 v[10:13], v8 offset:20480
    v_mfma_f32_16x16x32_bf16 v[192:195], v[72:75], v[30:33], v[192:195]
    ds_read_b128 v[14:17], v8 offset:21504
    s_waitcnt lgkmcnt(6)
    v_mfma_f32_16x16x32_bf16 v[192:195], v[80:83], v[34:37], v[192:195]
    ds_read_b128 v[18:21], v8 offset:22528
    v_mfma_f32_16x16x32_bf16 v[192:195], v[88:91], v[38:41], v[192:195]
    ds_read_b128 v[22:25], v8 offset:23552
    v_mfma_f32_16x16x32_bf16 v[196:199], v[68:71], v[26:29], v[196:199]
    ds_read_b64_tr_b16 v[104:105], v6 offset:40960
    v_mfma_f32_16x16x32_bf16 v[196:199], v[76:79], v[30:33], v[196:199]
    ds_read_b64_tr_b16 v[106:107], v6 offset:45056
    v_mfma_f32_16x16x32_bf16 v[196:199], v[84:87], v[34:37], v[196:199]
    ds_read_b64_tr_b16 v[108:109], v7 offset:40960
    v_mfma_f32_16x16x32_bf16 v[196:199], v[92:95], v[38:41], v[196:199]
    ds_read_b64_tr_b16 v[110:111], v7 offset:45056
    s_waitcnt lgkmcnt(6)
    v_mfma_f32_16x16x32_bf16 v[200:203], v[64:67], v[10:13], v[200:203]
    ds_read_b128 v[26:29], v8 offset:24576
    v_mfma_f32_16x16x32_bf16 v[200:203], v[72:75], v[14:17], v[200:203]
    ds_read_b128 v[30:33], v8 offset:25600
    s_waitcnt lgkmcnt(6)
    v_mfma_f32_16x16x32_bf16 v[200:203], v[80:83], v[18:21], v[200:203]
    ds_read_b128 v[34:37], v8 offset:26624
    v_mfma_f32_16x16x32_bf16 v[200:203], v[88:91], v[22:25], v[200:203]
    ds_read_b128 v[38:41], v8 offset:27648
    v_mfma_f32_16x16x32_bf16 v[204:207], v[68:71], v[10:13], v[204:207]
    ds_read_b64_tr_b16 v[112:113], v6 offset:49152
    v_mfma_f32_16x16x32_bf16 v[204:207], v[76:79], v[14:17], v[204:207]
    ds_read_b64_tr_b16 v[114:115], v6 offset:53248
    v_mfma_f32_16x16x32_bf16 v[204:207], v[84:87], v[18:21], v[204:207]
    ds_read_b64_tr_b16 v[116:117], v7 offset:49152
    v_mfma_f32_16x16x32_bf16 v[204:207], v[92:95], v[22:25], v[204:207]
    ds_read_b64_tr_b16 v[118:119], v7 offset:53248
    s_waitcnt lgkmcnt(6)
    v_mfma_f32_16x16x32_bf16 v[208:211], v[64:67], v[26:29], v[208:211]
    ds_read_b128 v[10:13], v8 offset:28672
    v_mfma_f32_16x16x32_bf16 v[208:211], v[72:75], v[30:33], v[208:211]
    ds_read_b128 v[14:17], v8 offset:29696
    s_waitcnt lgkmcnt(6)
    v_mfma_f32_16x16x32_bf16 v[208:211], v[80:83], v[34:37], v[208:211]
    ds_read_b128 v[18:21], v8 offset:30720
    v_mfma_f32_16x16x32_bf16 v[208:211], v[88:91], v[38:41], v[208:211]
    ds_read_b128 v[22:25], v8 offset:31744
    v_mfma_f32_16x16x32_bf16 v[212:215], v[68:71], v[26:29], v[212:215]
    ds_read_b64_tr_b16 v[120:121], v6 offset:57344
    v_mfma_f32_16x16x32_bf16 v[212:215], v[76:79], v[30:33], v[212:215]
    ds_read_b64_tr_b16 v[122:123], v6 offset:61440
    v_mfma_f32_16x16x32_bf16 v[212:215], v[84:87], v[34:37], v[212:215]
    ds_read_b64_tr_b16 v[124:125], v7 offset:57344
    v_mfma_f32_16x16x32_bf16 v[212:215], v[92:95], v[38:41], v[212:215]
    ds_read_b64_tr_b16 v[126:127], v7 offset:61440
    s_barrier
    s_waitcnt lgkmcnt(6)
    v_mfma_f32_16x16x32_bf16 v[216:219], v[64:67], v[10:13], v[216:219]
    ds_read_b128 v[26:29], v8 offset:32768
    v_mfma_f32_16x16x32_bf16 v[216:219], v[72:75], v[14:17], v[216:219]
    ds_read_b128 v[30:33], v8 offset:33792
    s_waitcnt lgkmcnt(6)
    v_mfma_f32_16x16x32_bf16 v[216:219], v[80:83], v[18:21], v[216:219]
    ds_read_b128 v[34:37], v8 offset:34816
    v_mfma_f32_16x16x32_bf16 v[216:219], v[88:91], v[22:25], v[216:219]
    ds_read_b128 v[38:41], v8 offset:35840
    v_mfma_f32_16x16x32_bf16 v[220:223], v[68:71], v[10:13], v[220:223]
    v_mfma_f32_16x16x32_bf16 v[220:223], v[76:79], v[14:17], v[220:223]
    v_mfma_f32_16x16x32_bf16 v[220:223], v[84:87], v[18:21], v[220:223]
    v_mfma_f32_16x16x32_bf16 v[220:223], v[92:95], v[22:25], v[220:223]
    s_waitcnt lgkmcnt(2)
    v_mfma_f32_16x16x32_bf16 v[192:195], v[96:99], v[26:29], v[192:195]
    ds_read_b128 v[10:13], v8 offset:36864
    v_mfma_f32_16x16x32_bf16 v[192:195], v[104:107], v[30:33], v[192:195]
    ds_read_b128 v[14:17], v8 offset:37888
    s_waitcnt lgkmcnt(2)
    v_mfma_f32_16x16x32_bf16 v[192:195], v[112:115], v[34:37], v[192:195]
    ds_read_b128 v[18:21], v8 offset:38912
    v_mfma_f32_16x16x32_bf16 v[192:195], v[120:123], v[38:41], v[192:195]
    ds_read_b128 v[22:25], v8 offset:39936
    v_mfma_f32_16x16x32_bf16 v[196:199], v[100:103], v[26:29], v[196:199]
    v_mfma_f32_16x16x32_bf16 v[196:199], v[108:111], v[30:33], v[196:199]
    v_mfma_f32_16x16x32_bf16 v[196:199], v[116:119], v[34:37], v[196:199]
    v_mfma_f32_16x16x32_bf16 v[196:199], v[124:127], v[38:41], v[196:199]
    s_waitcnt lgkmcnt(2)
    v_mfma_f32_16x16x32_bf16 v[200:203], v[96:99], v[10:13], v[200:203]
    ds_read_b128 v[26:29], v8 offset:40960
    v_mfma_f32_16x16x32_bf16 v[200:203], v[104:107], v[14:17], v[200:203]
    ds_read_b128 v[30:33], v8 offset:41984
    s_waitcnt lgkmcnt(2)
    v_mfma_f32_16x16x32_bf16 v[200:203], v[112:115], v[18:21], v[200:203]
    ds_read_b128 v[34:37], v8 offset:43008
    v_cvt_pk_bf16_f32 v44, v192, v193
    v_mfma_f32_16x16x32_bf16 v[200:203], v[120:123], v[22:25], v[200:203]
    ds_read_b128 v[38:41], v8 offset:44032
    v_cvt_pk_bf16_f32 v45, v194, v195
    v_mfma_f32_16x16x32_bf16 v[204:207], v[100:103], v[10:13], v[204:207]
    v_cvt_pk_bf16_f32 v46, v196, v197
    v_cvt_pk_bf16_f32 v47, v198, v199
    v_mfma_f32_16x16x32_bf16 v[204:207], v[108:111], v[14:17], v[204:207]
    buffer_store_dwordx4 v[44:47], v0, s[56:59], s36 offen sc1
    v_mfma_f32_16x16x32_bf16 v[204:207], v[116:119], v[18:21], v[204:207]
    v_mfma_f32_16x16x32_bf16 v[204:207], v[124:127], v[22:25], v[204:207]
    s_waitcnt lgkmcnt(2)
    v_mfma_f32_16x16x32_bf16 v[208:211], v[96:99], v[26:29], v[208:211]
    ds_read_b128 v[10:13], v8 offset:45056
    v_mfma_f32_16x16x32_bf16 v[208:211], v[104:107], v[30:33], v[208:211]
    ds_read_b128 v[14:17], v8 offset:46080
    s_waitcnt lgkmcnt(2)
    v_mfma_f32_16x16x32_bf16 v[208:211], v[112:115], v[34:37], v[208:211]
    ds_read_b128 v[18:21], v8 offset:47104
    v_cvt_pk_bf16_f32 v48, v200, v201
    v_mfma_f32_16x16x32_bf16 v[208:211], v[120:123], v[38:41], v[208:211]
    ds_read_b128 v[22:25], v8 offset:48128
    v_cvt_pk_bf16_f32 v49, v202, v203
    v_mfma_f32_16x16x32_bf16 v[212:215], v[100:103], v[26:29], v[212:215]
    v_cvt_pk_bf16_f32 v50, v204, v205
    v_cvt_pk_bf16_f32 v51, v206, v207
    v_mfma_f32_16x16x32_bf16 v[212:215], v[108:111], v[30:33], v[212:215]
    buffer_store_dwordx4 v[48:51], v0, s[56:59], s37 offen sc1
    v_mfma_f32_16x16x32_bf16 v[212:215], v[116:119], v[34:37], v[212:215]
    v_mfma_f32_16x16x32_bf16 v[212:215], v[124:127], v[38:41], v[212:215]
    s_barrier
    s_waitcnt lgkmcnt(2)
    v_mfma_f32_16x16x32_bf16 v[216:219], v[96:99], v[10:13], v[216:219]
    ds_read_b128 v[26:29], v8 offset:49152
    v_mfma_f32_16x16x32_bf16 v[216:219], v[104:107], v[14:17], v[216:219]
    ds_read_b128 v[30:33], v8 offset:50176
    s_waitcnt lgkmcnt(2)
    v_mfma_f32_16x16x32_bf16 v[216:219], v[112:115], v[18:21], v[216:219]
    ds_read_b128 v[34:37], v8 offset:51200
    v_cvt_pk_bf16_f32 v44, v208, v209
    v_mfma_f32_16x16x32_bf16 v[216:219], v[120:123], v[22:25], v[216:219]
    ds_read_b128 v[38:41], v8 offset:52224
    v_cvt_pk_bf16_f32 v45, v210, v211
    v_mfma_f32_16x16x32_bf16 v[220:223], v[100:103], v[10:13], v[220:223]
    v_cvt_pk_bf16_f32 v46, v212, v213
    v_cvt_pk_bf16_f32 v47, v214, v215
    v_mfma_f32_16x16x32_bf16 v[220:223], v[108:111], v[14:17], v[220:223]
    buffer_store_dwordx4 v[44:47], v0, s[56:59], s38 offen sc1
    v_mfma_f32_16x16x32_bf16 v[220:223], v[116:119], v[18:21], v[220:223]
    v_mfma_f32_16x16x32_bf16 v[220:223], v[124:127], v[22:25], v[220:223]
    s_waitcnt lgkmcnt(2)
    v_mfma_f32_16x16x32_bf16 v[224:227], v[160:163], v[26:29], v[224:227]
    ds_read_b128 v[10:13], v8 offset:53248
    v_mfma_f32_16x16x32_bf16 v[224:227], v[168:171], v[30:33], v[224:227]
    ds_read_b128 v[14:17], v8 offset:54272
    s_waitcnt lgkmcnt(2)
    v_mfma_f32_16x16x32_bf16 v[224:227], v[176:179], v[34:37], v[224:227]
    ds_read_b128 v[18:21], v8 offset:55296
    v_cvt_pk_bf16_f32 v48, v216, v217
    v_mfma_f32_16x16x32_bf16 v[224:227], v[184:187], v[38:41], v[224:227]
    ds_read_b128 v[22:25], v8 offset:56320
    v_cvt_pk_bf16_f32 v49, v218, v219
    v_mfma_f32_16x16x32_bf16 v[228:231], v[164:167], v[26:29], v[228:231]
    v_cvt_pk_bf16_f32 v50, v220, v221
    v_cvt_pk_bf16_f32 v51, v222, v223
    v_mfma_f32_16x16x32_bf16 v[228:231], v[172:175], v[30:33], v[228:231]
    buffer_store_dwordx4 v[48:51], v0, s[56:59], s39 offen sc1
    v_mfma_f32_16x16x32_bf16 v[228:231], v[180:183], v[34:37], v[228:231]
    v_mfma_f32_16x16x32_bf16 v[228:231], v[188:191], v[38:41], v[228:231]
    s_waitcnt lgkmcnt(2)
    v_mfma_f32_16x16x32_bf16 v[232:235], v[160:163], v[10:13], v[232:235]
    ds_read_b128 v[26:29], v8 offset:57344
    v_mfma_f32_16x16x32_bf16 v[232:235], v[168:171], v[14:17], v[232:235]
    ds_read_b128 v[30:33], v8 offset:58368
    s_waitcnt lgkmcnt(2)
    v_mfma_f32_16x16x32_bf16 v[232:235], v[176:179], v[18:21], v[232:235]
    ds_read_b128 v[34:37], v8 offset:59392
    v_mfma_f32_16x16x32_bf16 v[232:235], v[184:187], v[22:25], v[232:235]
    ds_read_b128 v[38:41], v8 offset:60416
    v_mfma_f32_16x16x32_bf16 v[236:239], v[164:167], v[10:13], v[236:239]
    v_mfma_f32_16x16x32_bf16 v[236:239], v[172:175], v[14:17], v[236:239]
    v_mfma_f32_16x16x32_bf16 v[236:239], v[180:183], v[18:21], v[236:239]
    v_mfma_f32_16x16x32_bf16 v[236:239], v[188:191], v[22:25], v[236:239]
    s_branch L_pg5
.p2align 12
L_pad5:
    s_branch L_compute
    s_nop 0
L_pg5:
    s_barrier
    s_waitcnt lgkmcnt(2)
    v_mfma_f32_16x16x32_bf16 v[240:243], v[160:163], v[26:29], v[240:243]
    ds_read_b128 v[10:13], v9 offset:32768
    v_mfma_f32_16x16x32_bf16 v[240:243], v[168:171], v[30:33], v[240:243]
    ds_read_b128 v[14:17], v9 offset:33792
    s_waitcnt lgkmcnt(2)
    v_mfma_f32_16x16x32_bf16 v[240:243], v[176:179], v[34:37], v[240:243]
    ds_read_b128 v[18:21], v9 offset:34816
    v_mfma_f32_16x16x32_bf16 v[240:243], v[184:187], v[38:41], v[240:243]
    ds_read_b128 v[22:25], v9 offset:35840
    v_mfma_f32_16x16x32_bf16 v[244:247], v[164:167], v[26:29], v[244:247]
    v_mfma_f32_16x16x32_bf16 v[244:247], v[172:175], v[30:33], v[244:247]
    v_mfma_f32_16x16x32_bf16 v[244:247], v[180:183], v[34:37], v[244:247]
    v_mfma_f32_16x16x32_bf16 v[244:247], v[188:191], v[38:41], v[244:247]
    s_waitcnt lgkmcnt(2)
    v_mfma_f32_16x16x32_bf16 v[224:227], v[64:67], v[10:13], v[224:227]
    ds_read_b128 v[26:29], v9 offset:49152
    v_mfma_f32_16x16x32_bf16 v[224:227], v[72:75], v[14:17], v[224:227]
    ds_read_b128 v[30:33], v9 offset:50176
    s_waitcnt lgkmcnt(2)
    v_mfma_f32_16x16x32_bf16 v[224:227], v[80:83], v[18:21], v[224:227]
    ds_read_b128 v[34:37], v9 offset:51200
    v_mfma_f32_16x16x32_bf16 v[224:227], v[88:91], v[22:25], v[224:227]
    ds_read_b128 v[38:41], v9 offset:52224
    v_mfma_f32_16x16x32_bf16 v[228:231], v[68:71], v[10:13], v[228:231]
    v_mfma_f32_16x16x32_bf16 v[228:231], v[76:79], v[14:17], v[228:231]
    v_mfma_f32_16x16x32_bf16 v[228:231], v[84:87], v[18:21], v[228:231]
    v_mfma_f32_16x16x32_bf16 v[228:231], v[92:95], v[22:25], v[228:231]
    s_waitcnt lgkmcnt(2)
    v_mfma_f32_16x16x32_bf16 v[224:227], v[96:99], v[26:29], v[224:227]
    ds_read_b128 v[10:13], v9 offset:36864
    v_mfma_f32_16x16x32_bf16 v[224:227], v[104:107], v[30:33], v[224:227]
    ds_read_b128 v[14:17], v9 offset:37888
    s_waitcnt lgkmcnt(2)
    v_mfma_f32_16x16x32_bf16 v[224:227], v[112:115], v[34:37], v[224:227]
    ds_read_b128 v[18:21], v9 offset:38912
    v_mfma_f32_16x16x32_bf16 v[224:227], v[120:123], v[38:41], v[224:227]
    ds_read_b128 v[22:25], v9 offset:39936
    v_mfma_f32_16x16x32_bf16 v[228:231], v[100:103], v[26:29], v[228:231]
    v_mfma_f32_16x16x32_bf16 v[228:231], v[108:111], v[30:33], v[228:231]
    v_mfma_f32_16x16x32_bf16 v[228:231], v[116:119], v[34:37], v[228:231]
    v_mfma_f32_16x16x32_bf16 v[228:231], v[124:127], v[38:41], v[228:231]
    s_waitcnt lgkmcnt(2)
    v_mfma_f32_16x16x32_bf16 v[232:235], v[64:67], v[10:13], v[232:235]
    ds_read_b128 v[26:29], v9 offset:53248
    v_mfma_f32_16x16x32_bf16 v[232:235], v[72:75], v[14:17], v[232:235]
    ds_read_b128 v[30:33], v9 offset:54272
    s_waitcnt lgkmcnt(2)
    v_mfma_f32_16x16x32_bf16 v[232:235], v[80:83], v[18:21], v[232:235]
    ds_read_b128 v[34:37], v9 offset:55296
    v_cvt_pk_bf16_f32 v44, v224, v225
    v_mfma_f32_16x16x32_bf16 v[232:235], v[88:91], v[22:25], v[232:235]
    ds_read_b128 v[38:41], v9 offset:56320
    v_cvt_pk_bf16_f32 v45, v226, v227
    v_mfma_f32_16x16x32_bf16 v[236:239], v[68:71], v[10:13], v[236:239]
    v_cvt_pk_bf16_f32 v46, v228, v229
    v_cvt_pk_bf16_f32 v47, v230, v231
    v_mfma_f32_16x16x32_bf16 v[236:239], v[76:79], v[14:17], v[236:239]
    buffer_store_dwordx4 v[44:47], v0, s[56:59], s40 offen sc1
    v_mfma_f32_16x16x32_bf16 v[236:239], v[84:87], v[18:21], v[236:239]
    v_mfma_f32_16x16x32_bf16 v[236:239], v[92:95], v[22:25], v[236:239]
    v_mov_b32 v62, 1
    s_mov_b64 exec, 15
    s_waitcnt vmcnt(1)
    buffer_store_dword v62, v1, s[56:59], s15 offen sc1
    s_mov_b64 exec, -1
    s_waitcnt lgkmcnt(2)
    v_mfma_f32_16x16x32_bf16 v[232:235], v[96:99], v[26:29], v[232:235]
    ds_read_b128 v[10:13], v9 offset:40960
    v_mfma_f32_16x16x32_bf16 v[232:235], v[104:107], v[30:33], v[232:235]
    ds_read_b128 v[14:17], v9 offset:41984
    s_waitcnt lgkmcnt(2)
    v_mfma_f32_16x16x32_bf16 v[232:235], v[112:115], v[34:37], v[232:235]
    ds_read_b128 v[18:21], v9 offset:43008
    v_mfma_f32_16x16x32_bf16 v[232:235], v[120:123], v[38:41], v[232:235]
    ds_read_b128 v[22:25], v9 offset:44032
    v_mfma_f32_16x16x32_bf16 v[236:239], v[100:103], v[26:29], v[236:239]
    v_mfma_f32_16x16x32_bf16 v[236:239], v[108:111], v[30:33], v[236:239]
    v_mfma_f32_16x16x32_bf16 v[236:239], v[116:119], v[34:37], v[236:239]
    v_mfma_f32_16x16x32_bf16 v[236:239], v[124:127], v[38:41], v[236:239]
    s_waitcnt lgkmcnt(2)
    v_mfma_f32_16x16x32_bf16 v[240:243], v[64:67], v[10:13], v[240:243]
    ds_read_b128 v[26:29], v9 offset:57344
    v_mfma_f32_16x16x32_bf16 v[240:243], v[72:75], v[14:17], v[240:243]
    ds_read_b128 v[30:33], v9 offset:58368
    s_waitcnt lgkmcnt(2)
    v_mfma_f32_16x16x32_bf16 v[240:243], v[80:83], v[18:21], v[240:243]
    ds_read_b128 v[34:37], v9 offset:59392
    v_cvt_pk_bf16_f32 v48, v232, v233
    v_mfma_f32_16x16x32_bf16 v[240:243], v[88:91], v[22:25], v[240:243]
    ds_read_b128 v[38:41], v9 offset:60416
    v_cvt_pk_bf16_f32 v49, v234, v235
    v_mfma_f32_16x16x32_bf16 v[244:247], v[68:71], v[10:13], v[244:247]
    v_cvt_pk_bf16_f32 v50, v236, v237
    v_cvt_pk_bf16_f32 v51, v238, v239
    v_mfma_f32_16x16x32_bf16 v[244:247], v[76:79], v[14:17], v[244:247]
    buffer_store_dwordx4 v[48:51], v0, s[56:59], s41 offen sc1
    v_mfma_f32_16x16x32_bf16 v[244:247], v[84:87], v[18:21], v[244:247]
    v_mfma_f32_16x16x32_bf16 v[244:247], v[92:95], v[22:25], v[244:247]
    s_waitcnt lgkmcnt(2)
    v_mfma_f32_16x16x32_bf16 v[240:243], v[96:99], v[26:29], v[240:243]
    ds_read_b128 v[10:13], v9 offset:28672
    v_mfma_f32_16x16x32_bf16 v[240:243], v[104:107], v[30:33], v[240:243]
    ds_read_b128 v[14:17], v9 offset:29696
    s_waitcnt lgkmcnt(2)
    v_mfma_f32_16x16x32_bf16 v[240:243], v[112:115], v[34:37], v[240:243]
    ds_read_b128 v[18:21], v9 offset:30720
    v_mfma_f32_16x16x32_bf16 v[240:243], v[120:123], v[38:41], v[240:243]
    ds_read_b128 v[22:25], v9 offset:31744
    v_mfma_f32_16x16x32_bf16 v[244:247], v[100:103], v[26:29], v[244:247]
    v_mfma_f32_16x16x32_bf16 v[244:247], v[108:111], v[30:33], v[244:247]
    v_mfma_f32_16x16x32_bf16 v[244:247], v[116:119], v[34:37], v[244:247]
    v_mfma_f32_16x16x32_bf16 v[244:247], v[124:127], v[38:41], v[244:247]
    s_nop 2
    v_cvt_pk_bf16_f32 v44, v240, v241
    v_cvt_pk_bf16_f32 v45, v242, v243
    s_nop 2
    v_cvt_pk_bf16_f32 v46, v244, v245
    v_cvt_pk_bf16_f32 v47, v246, v247
    buffer_store_dwordx4 v[44:47], v0, s[56:59], s42 offen sc1
    s_waitcnt lgkmcnt(2)
    v_mfma_f32_16x16x32_bf16 v[248:251], v[128:131], v[10:13], 0
    ds_read_b128 v[26:29], v8 offset:61440
    v_mfma_f32_16x16x32_bf16 v[248:251], v[136:139], v[14:17], v[248:251]
    ds_read_b128 v[30:33], v8 offset:62464
    s_waitcnt lgkmcnt(2)
    v_mfma_f32_16x16x32_bf16 v[248:251], v[144:147], v[18:21], v[248:251]
    ds_read_b128 v[34:37], v8 offset:63488
    v_mfma_f32_16x16x32_bf16 v[248:251], v[152:155], v[22:25], v[248:251]
    ds_read_b128 v[38:41], v8 offset:64512
    v_mfma_f32_16x16x32_bf16 v[252:255], v[132:135], v[10:13], 0
    v_mfma_f32_16x16x32_bf16 v[252:255], v[140:143], v[14:17], v[252:255]
    v_mfma_f32_16x16x32_bf16 v[252:255], v[148:151], v[18:21], v[252:255]
    v_mfma_f32_16x16x32_bf16 v[252:255], v[156:159], v[22:25], v[252:255]
    s_waitcnt lgkmcnt(2)
    v_mfma_f32_16x16x32_bf16 v[248:251], v[160:163], v[26:29], v[248:251]
    ds_read_b128 v[10:13], v9 offset:45056
    v_mfma_f32_16x16x32_bf16 v[248:251], v[168:171], v[30:33], v[248:251]
    ds_read_b128 v[14:17], v9 offset:46080
    s_waitcnt lgkmcnt(2)
    v_mfma_f32_16x16x32_bf16 v[248:251], v[176:179], v[34:37], v[248:251]
    ds_read_b128 v[18:21], v9 offset:47104
    v_mfma_f32_16x16x32_bf16 v[248:251], v[184:187], v[38:41], v[248:251]
    ds_read_b128 v[22:25], v9 offset:48128
    v_mfma_f32_16x16x32_bf16 v[252:255], v[164:167], v[26:29], v[252:255]
    v_mfma_f32_16x16x32_bf16 v[252:255], v[172:175], v[30:33], v[252:255]
    v_mfma_f32_16x16x32_bf16 v[252:255], v[180:183], v[34:37], v[252:255]
    v_mfma_f32_16x16x32_bf16 v[252:255], v[188:191], v[38:41], v[252:255]
    s_waitcnt lgkmcnt(2)
    v_mfma_f32_16x16x32_bf16 v[248:251], v[64:67], v[10:13], v[248:251]
    ds_read_b128 v[26:29], v9 offset:61440
    v_mfma_f32_16x16x32_bf16 v[248:251], v[72:75], v[14:17], v[248:251]
    ds_read_b128 v[30:33], v9 offset:62464
    s_waitcnt lgkmcnt(2)
    v_mfma_f32_16x16x32_bf16 v[248:251], v[80:83], v[18:21], v[248:251]
    ds_read_b128 v[34:37], v9 offset:63488
    v_mfma_f32_16x16x32_bf16 v[248:251], v[88:91], v[22:25], v[248:251]
    ds_read_b128 v[38:41], v9 offset:64512
    v_mfma_f32_16x16x32_bf16 v[252:255], v[68:71], v[10:13], v[252:255]
    v_mfma_f32_16x16x32_bf16 v[252:255], v[76:79], v[14:17], v[252:255]
    v_mfma_f32_16x16x32_bf16 v[252:255], v[84:87], v[18:21], v[252:255]
    v_mfma_f32_16x16x32_bf16 v[252:255], v[92:95], v[22:25], v[252:255]
    s_waitcnt lgkmcnt(2)
    v_mfma_f32_16x16x32_bf16 v[248:251], v[96:99], v[26:29], v[248:251]
    v_mfma_f32_16x16x32_bf16 v[248:251], v[104:107], v[30:33], v[248:251]
    s_waitcnt lgkmcnt(0)
    v_mfma_f32_16x16x32_bf16 v[248:251], v[112:115], v[34:37], v[248:251]
    v_mfma_f32_16x16x32_bf16 v[248:251], v[120:123], v[38:41], v[248:251]
    v_mfma_f32_16x16x32_bf16 v[252:255], v[100:103], v[26:29], v[252:255]
    v_mfma_f32_16x16x32_bf16 v[252:255], v[108:111], v[30:33], v[252:255]
    v_mfma_f32_16x16x32_bf16 v[252:255], v[116:119], v[34:37], v[252:255]
    v_mfma_f32_16x16x32_bf16 v[252:255], v[124:127], v[38:41], v[252:255]
    s_mov_b64 exec, 48
    s_waitcnt vmcnt(1)
    buffer_store_dword v62, v1, s[56:59], s15 offen sc1
    s_mov_b64 exec, -1
    s_mov_b64 exec, 64
    s_waitcnt vmcnt(1)
    buffer_store_dword v62, v1, s[56:59], s15 offen sc1
    s_mov_b64 exec, -1
    s_lshl_b32 s9, s3, 11
    s_add_u32 s9, s9, 73728
    v_add_u32 v61, s9, v0
    ds_write_b128 v61, v[248:251] offset:0
    ds_write_b128 v61, v[252:255] offset:1024
    v_lshrrev_b32 v0, 4, v2
    s_mov_b32 s9, s3
    s_mov_b64 s[52:53], s[26:27]
    s_mov_b32 s54, 0x100000
    s_mov_b32 s55, 0x20000
    s_lshl_b32 s10, s2, 2
    s_add_u32 s10, s10, s9
    s_lshl_b32 s10, s10, 8
    s_add_u32 s10, s10, 16777216
    s_add_u32 s16, s30, s10
    s_addc_u32 s17, s31, 0
    s_lshl_b32 s10, s2, 5
    s_add_u32 s10, s10, s9
    s_lshl_b32 s10, s10, 10
    v_lshl_add_u32 v52, v0, 4, s10
    s_lshl_b32 s10, s9, 11
    s_add_u32 s10, s10, 65536
    v_lshl_add_u32 v53, v0, 4, s10
    v_lshrrev_b32 v54, 2, v0
    v_and_b32 v55, 3, v0
    v_lshlrev_b32 v55, 4, v55
    v_lshl_add_u32 v54, v54, 10, v55
    s_lshl_b32 s10, s7, 3
    s_add_u32 s10, s10, s4
    s_lshl_b32 s10, s10, 6
    s_add_u32 s10, s10, s6
    s_lshl_b32 s10, s10, 2
    s_add_u32 s10, s10, s9
    s_lshl_b32 s10, s10, 6
    v_add_u32 v54, s10, v54
    s_waitcnt lgkmcnt(0)
    ds_read_b128 v[248:251], v53 offset:8192
    ds_read_b128 v[252:255], v53 offset:9216
    s_mov_b32 s65, 0x40000
L_poll5:
    s_load_dwordx4 s[20:23], s[16:17], 128 glc
    s_waitcnt lgkmcnt(0)
L_pollin5:
    s_min_u32 s20, s20, s21
    s_cmp_ge_u32 s20, 1
    s_cbranch_scc1 L_pollok5
    s_sub_u32 s65, s65, 1
    s_cbranch_scc0 L_poll5
L_pollok5:
    s_mov_b32 s64, 8404992
    buffer_load_dwordx4 v[32:35], v52, s[56:59], s64 offen sc1
    s_mov_b32 s64, 8409088
    buffer_load_dwordx4 v[36:39], v52, s[56:59], s64 offen sc1
    s_mov_b32 s65, 0x40000
    s_branch L_pollin6
L_poll6:
    s_load_dwordx4 s[20:23], s[16:17], 128 glc
    s_waitcnt lgkmcnt(0)
L_pollin6:
    s_cmp_ge_u32 s22, 1
    s_cbranch_scc1 L_pollok6
    s_sub_u32 s65, s65, 1
    s_cbranch_scc0 L_poll6
L_pollok6:
    s_mov_b32 s64, 8413184
    buffer_load_dwordx4 v[40:43], v52, s[56:59], s64 offen sc1
    s_barrier
    ds_read_b128 v[64:67], v53
    ds_read_b128 v[68:71], v53 offset:1024
    s_waitcnt lgkmcnt(0)
    v_pk_add_f32 v[248:249], v[248:249], v[64:65]
    v_pk_add_f32 v[250:251], v[250:251], v[66:67]
    v_pk_add_f32 v[252:253], v[252:253], v[68:69]
    v_pk_add_f32 v[254:255], v[254:255], v[70:71]
    s_waitcnt vmcnt(2)
    v_lshlrev_b32 v64, 16, v32
    v_and_b32 v65, 0xffff0000, v32
    v_lshlrev_b32 v66, 16, v33
    v_and_b32 v67, 0xffff0000, v33
    v_lshlrev_b32 v68, 16, v34
    v_and_b32 v69, 0xffff0000, v34
    v_lshlrev_b32 v70, 16, v35
    v_and_b32 v71, 0xffff0000, v35
    v_pk_add_f32 v[248:249], v[248:249], v[64:65]
    v_pk_add_f32 v[250:251], v[250:251], v[66:67]
    v_pk_add_f32 v[252:253], v[252:253], v[68:69]
    v_pk_add_f32 v[254:255], v[254:255], v[70:71]
    s_waitcnt vmcnt(1)
    v_lshlrev_b32 v64, 16, v36
    v_and_b32 v65, 0xffff0000, v36
    v_lshlrev_b32 v66, 16, v37
    v_and_b32 v67, 0xffff0000, v37
    v_lshlrev_b32 v68, 16, v38
    v_and_b32 v69, 0xffff0000, v38
    v_lshlrev_b32_e64 v70, 16, v39
    v_and_b32 v71, 0xffff0000, v39
    v_pk_add_f32 v[248:249], v[248:249], v[64:65]
    v_pk_add_f32 v[250:251], v[250:251], v[66:67]
    v_pk_add_f32 v[252:253], v[252:253], v[68:69]
    v_pk_add_f32 v[254:255], v[254:255], v[70:71]
    s_waitcnt vmcnt(0)
    v_lshlrev_b32 v64, 16, v40
    v_and_b32 v65, 0xffff0000, v40
    v_lshlrev_b32 v66, 16, v41
    v_and_b32 v67, 0xffff0000, v41
    v_lshlrev_b32 v68, 16, v42
    v_and_b32 v69, 0xffff0000, v42
    v_lshlrev_b32_e64 v70, 16, v43
    v_and_b32 v71, 0xffff0000, v43
    v_pk_add_f32 v[248:249], v[248:249], v[64:65]
    v_pk_add_f32 v[250:251], v[250:251], v[66:67]
    v_pk_add_f32 v[252:253], v[252:253], v[68:69]
    v_pk_add_f32 v[254:255], v[254:255], v[70:71]
    v_cvt_pk_bf16_f32 v56, v248, v249
    v_cvt_pk_bf16_f32 v58, v252, v253
    v_cvt_pk_bf16_f32 v57, v250, v251
    v_cvt_pk_bf16_f32 v59, v254, v255
    buffer_store_dwordx4 v[56:59], v54, s[52:55], 0 offen sc1
    s_endpgm
.section .rodata,"a"
.p2align 6
.amdhsa_kernel standalone__mha_block_cached__near_ridge_kernel
  .amdhsa_next_free_vgpr 256
  .amdhsa_next_free_sgpr 102
  .amdhsa_accum_offset 256
  .amdhsa_group_segment_fixed_size 0
  .amdhsa_kernarg_size 64
  .amdhsa_user_sgpr_count 2
  .amdhsa_user_sgpr_kernarg_segment_ptr 1
  .amdhsa_system_sgpr_workgroup_id_x 1
  .amdhsa_float_denorm_mode_32 3
.end_amdhsa_kernel
```
